```python
import torch

def _softmax(x, axis=-1):
    return torch.softmax(x, dim=axis)
def _gelu(x):
    return torch.nn.functional.gelu(x, approximate="tanh")
def _silu(x):
    return torch.nn.functional.silu(x)
def _sigmoid(x):
    return torch.sigmoid(x)
def _layernorm(x, axis=-1, eps=1e-5):
    m = x.mean(dim=axis, keepdim=True)
    v = x.var(dim=axis, keepdim=True, unbiased=False)
    return (x - m) / torch.sqrt(v + eps)
def _scatter_add(tgt, idx, src, axis=0):
    return tgt.clone().index_add_(axis, idx, src)
def _segment_sum(src, seg, n):
    out = torch.zeros((n,) + src.shape[1:], dtype=src.dtype)
    return out.index_add_(0, seg, src)
def _pad(x, pw):
    flat = tuple(v for pair in reversed(pw) for v in pair)
    return torch.nn.functional.pad(x, flat)

kernel_name = 'standalone__glu_gated_glu__prompt'

def setup_inputs():

    _w = (lambda a: (lambda t: t.to(torch.bfloat16) if t.is_floating_point() else t)(torch.as_tensor(a)))
    B, S, D, F = 1, 2048, 448, 1792
    return {
        "x": _w((lambda *s: torch.randn(*s, dtype=torch.bfloat16) * 0.2)(B, S, D)),
        "w_gate": _w((lambda *s: torch.randn(*s, dtype=torch.bfloat16) * 0.2)(D, F)),
        "w_up": _w((lambda *s: torch.randn(*s, dtype=torch.bfloat16) * 0.05)(D, F)),
        "w_down": _w((lambda *s: torch.randn(*s, dtype=torch.bfloat16) * 0.05)(F, D)),
    }

def reference(x, w_gate, w_up, w_down):
    g = torch.einsum("bsd,df->bsf", x, w_gate)
    u = torch.einsum("bsd,df->bsf", x, w_up)
    h = _sigmoid(g) * u
    return torch.einsum("bsf,fd->bsd", h, w_down)
```

```asm
; @launch grid=(256,1,1) block=(256,1,1) lds=163840
.amdgcn_target "amdgcn-amd-amdhsa--gfx950"
.text
.globl standalone__glu_gated_glu__prompt_kernel
.p2align 8
.type standalone__glu_gated_glu__prompt_kernel,@function
standalone__glu_gated_glu__prompt_kernel:
    s_load_dwordx8 s[4:11], s[0:1], 0
    s_load_dwordx4 s[12:15], s[0:1], 32
    s_load_dwordx2 s[16:17], s[0:1], 48
    s_sub_u32 s2, s2, 32
    s_cmp_lt_u32 s2, 224
    s_cbranch_scc1 L_main
    s_add_u32 s40, s2, 32
    s_cmp_ge_u32 s40, 32
    s_cbranch_scc1 L_end2
    s_getpc_b64 s[30:31]
    v_lshlrev_b32 v4, 7, v0
    v_cmp_gt_u32 vcc, 119, v0
    s_and_saveexec_b64 s[32:33], vcc
    s_cbranch_execz L_ncp
    global_load_dword v7, v4, s[30:31]
L_ncp:
    s_mov_b64 exec, -1
    s_branch L_help2
L_main:
    v_lshrrev_b32 v204, 6, v0
    v_and_b32 v0, 63, v0
    v_readfirstlane_b32 s42, v204
    s_and_b32 s51, s2, 7
    s_lshr_b32 s52, s2, 3
    s_mul_i32 s53, s52, 37
    s_lshr_b32 s53, s53, 8
    s_mul_i32 s54, s53, 7
    s_sub_u32 s54, s52, s54
    s_lshr_b32 s55, s51, 1
    s_lshl_b32 s40, s55, 2
    s_add_u32 s40, s40, s53
    s_and_b32 s56, s51, 1
    s_mul_i32 s41, s56, 7
    s_add_u32 s41, s41, s54
    s_lshl_b32 s56, s53, 1
    s_add_u32 s56, s56, s54
    s_add_u32 s56, s56, s55
    s_mul_i32 s57, s56, 37
    s_lshr_b32 s57, s57, 8
    s_mul_i32 s57, s57, 7
    s_sub_u32 s3, s56, s57
    v_lshrrev_b32 v204, 3, v0
    v_and_b32 v205, 7, v0
    v_lshrrev_b32 v206, 1, v204
    v_xor_b32 v207, v205, v206
    v_lshlrev_b32 v207, 4, v207
    v_mul_u32_u24 v208, 896, v204
    v_add_u32 v2, v208, v207
    v_xor_b32 v207, 64, v207
    s_movk_i32 s57, 6144
    v_add3_u32 v3, v208, v207, s57
    v_add_u32 v4, 12288, v2
    v_add_u32 v5, 12288, v3
    s_lshr_b32 s55, s42, 1
    v_and_b32 v209, 1, v206
    v_lshlrev_b32 v207, 5, v209
    v_lshlrev_b32 v205, 4, v205
    v_xor_b32 v207, v207, v205
    v_mul_u32_u24 v209, 3584, v204
    v_add_u32 v6, v209, v207
    v_xor_b32 v207, 64, v207
    s_movk_i32 s57, 27648
    v_add3_u32 v7, v209, v207, s57
    v_add_u32 v8, 55296, v6
    v_add_u32 v9, 55296, v7
    v_add_u32 v232, 128, v6
    v_add_u32 v233, 128, v7
    v_add_u32 v234, 128, v8
    v_add_u32 v235, 128, v9
    s_mul_i32 s18, s40, 114688
    s_mul_i32 s57, s42, 28672
    s_add_u32 s18, s18, s57
    s_and_b32 s57, s42, 1
    s_mul_i32 s19, s57, 114688
    s_lshl_b32 s58, s41, 8
    s_add_u32 s19, s19, s58
    s_lshl_b32 s46, s42, 12
    s_lshl_b32 s57, s3, 7
    s_add_u32 s64, s57, s18
    s_mul_i32 s57, s3, 229376
    s_add_u32 s71, s57, s19
    s_add_u32 s3, s3, 1
    s_cmp_eq_u32 s3, 7
    s_cselect_b32 s3, 0, s3
    s_lshl_b32 s57, s3, 7
    s_add_u32 s65, s57, s18
    s_mul_i32 s57, s3, 229376
    s_add_u32 s72, s57, s19
    s_add_u32 s3, s3, 1
    s_cmp_eq_u32 s3, 7
    s_cselect_b32 s3, 0, s3
    s_mov_b32 s22, 1835008
    s_mov_b32 s23, 0x20000
    s_mov_b32 s26, 1605632
    s_mov_b32 s27, 0x20000
    s_waitcnt lgkmcnt(0)
    s_mov_b32 s20, s4
    s_and_b32 s21, s5, 0xffff
    s_cmp_eq_u32 s55, 0
    s_cselect_b32 s24, s6, s8
    s_cselect_b32 s25, s7, s9
    s_and_b32 s25, s25, 0xffff
    s_add_u32 m0, s46, 0x0
    s_nop 0
    buffer_load_dwordx4 v2, s[20:23], s64 offen lds
    buffer_load_dwordx4 v3, s[20:23], s64 offen offset:1024 lds
    buffer_load_dwordx4 v4, s[20:23], s64 offen offset:2048 lds
    buffer_load_dwordx4 v5, s[20:23], s64 offen offset:3072 lds
    s_add_u32 m0, s46, 0x4000
    s_nop 0
    buffer_load_dwordx4 v6, s[24:27], s71 offen lds
    buffer_load_dwordx4 v7, s[24:27], s71 offen offset:1024 lds
    buffer_load_dwordx4 v8, s[24:27], s71 offen offset:2048 lds
    buffer_load_dwordx4 v9, s[24:27], s71 offen offset:3072 lds
    s_add_u32 m0, s46, 0x8000
    s_nop 0
    buffer_load_dwordx4 v2, s[20:23], s65 offen lds
    buffer_load_dwordx4 v3, s[20:23], s65 offen offset:1024 lds
    s_lshl_b32 s57, s3, 7
    s_add_u32 s66, s57, s18
    s_mul_i32 s57, s3, 229376
    s_add_u32 s73, s57, s19
    s_add_u32 s3, s3, 1
    s_cmp_eq_u32 s3, 7
    s_cselect_b32 s3, 0, s3
    s_lshl_b32 s57, s3, 7
    s_add_u32 s67, s57, s18
    s_mul_i32 s57, s3, 229376
    s_add_u32 s74, s57, s19
    s_add_u32 s3, s3, 1
    s_cmp_eq_u32 s3, 7
    s_cselect_b32 s3, 0, s3
    s_lshl_b32 s57, s3, 7
    s_add_u32 s68, s57, s18
    s_mul_i32 s57, s3, 229376
    s_add_u32 s75, s57, s19
    s_add_u32 s3, s3, 1
    s_cmp_eq_u32 s3, 7
    s_cselect_b32 s3, 0, s3
    s_lshl_b32 s57, s3, 7
    s_add_u32 s69, s57, s18
    s_mul_i32 s57, s3, 229376
    s_add_u32 s76, s57, s19
    s_add_u32 s3, s3, 1
    s_cmp_eq_u32 s3, 7
    s_cselect_b32 s3, 0, s3
    s_lshl_b32 s57, s3, 7
    s_add_u32 s70, s57, s18
    s_mul_i32 s57, s3, 229376
    s_add_u32 s77, s57, s19
    s_add_u32 s3, s3, 1
    s_cmp_eq_u32 s3, 7
    s_cselect_b32 s3, 0, s3
    s_mul_i32 s59, s40, 1792
    s_lshl_b32 s61, s41, 2
    s_add_u32 s59, s59, s61
    s_add_u32 s59, s59, 0x800000
    v_lshl_add_u32 v23, v0, 7, s59
    s_lshl_b32 s43, s51, 2
    s_add_u32 s43, s43, s53
    s_mov_b32 s44, s54
    s_mov_b32 s28, s10
    s_and_b32 s29, s11, 0xffff
    s_mov_b32 s30, 1605632
    s_mov_b32 s31, 0x20000
    s_mov_b32 s32, s16
    s_and_b32 s33, s17, 0xffff
    s_mov_b32 s34, 7340032
    s_mov_b32 s35, 0x20000
    s_mov_b32 s36, s12
    s_and_b32 s37, s13, 0xffff
    s_mov_b32 s38, 1835008
    s_mov_b32 s39, 0x20000
    s_mov_b32 s4, 0xbfb8aa3b
    s_mov_b32 s5, 0xbfb8aa3b
    s_mov_b32 s6, 1.0
    s_mov_b32 s7, 1.0
    s_and_b32 s57, s42, 1
    s_lshr_b32 s58, s42, 1
    s_lshl_b32 s62, s58, 2
    s_add_u32 s62, s62, s57
    s_mul_i32 s48, s62, 28672
    s_lshl_b32 s59, s44, 7
    s_add_u32 s48, s48, s59
    v_lshlrev_b32 v207, 5, v206
    v_xor_b32 v207, v207, v205
    v_add_u32 v192, v208, v207
    v_add_u32 v193, 6144, v192
    v_add_u32 v194, 12288, v192
    v_add_u32 v195, 18432, v192
    v_lshlrev_b32 v22, 4, v0
    s_lshl_b32 s59, s40, 3
    s_lshl_b32 s60, s57, 2
    s_add_u32 s59, s59, s60
    s_mul_i32 s59, s59, 56
    s_lshl_b32 s60, s41, 2
    s_add_u32 s59, s59, s60
    s_add_u32 s59, s59, s58
    s_lshl_b32 s47, s59, 10
    s_mul_i32 s59, s43, 224
    s_add_u32 s59, s59, s62
    s_xor_b32 s60, s42, 0
    s_mul_i32 s60, s60, 56
    s_add_u32 s60, s60, s59
    s_lshl_b32 s60, s60, 10
    v_add_u32 v24, s60, v22
    s_xor_b32 s60, s42, 1
    s_mul_i32 s60, s60, 56
    s_add_u32 s60, s60, s59
    s_lshl_b32 s60, s60, 10
    v_add_u32 v25, s60, v22
    s_xor_b32 s60, s42, 2
    s_mul_i32 s60, s60, 56
    s_add_u32 s60, s60, s59
    s_lshl_b32 s60, s60, 10
    v_add_u32 v26, s60, v22
    s_xor_b32 s60, s42, 3
    s_mul_i32 s60, s60, 56
    s_add_u32 s60, s60, s59
    s_lshl_b32 s60, s60, 10
    v_add_u32 v27, s60, v22
    s_mul_i32 s59, s51, 28
    s_add_u32 s59, s59, s52
    s_mul_i32 s59, s59, 128
    s_add_u32 s59, s59, 0x800000
    v_min_u32 v196, 13, v0
    v_lshl_add_u32 v196, v196, 2, s59
    s_and_b32 s59, s51, 1
    s_lshl_b32 s59, s59, 7
    v_mov_b32 v197, s59
    v_mov_b32 v201, 1
    v_and_b32 v210, 15, v0
    v_lshrrev_b32 v211, 4, v0
    v_bfe_u32 v212, v0, 1, 3
    v_xor_b32 v212, v212, v211
    v_lshlrev_b32 v212, 4, v212
    v_lshl_add_u32 v212, v210, 7, v212
    s_lshl_b32 s59, s57, 13
    v_add_u32 v10, s59, v212
    v_xor_b32 v11, 64, v10
    v_add_u32 v12, 0x10000, v10
    v_add_u32 v14, 0x20000, v10
    v_add_u32 v13, 0x10000, v11
    v_add_u32 v15, 0x20000, v11
    v_bfe_u32 v213, v0, 2, 2
    v_and_b32 v214, 3, v0
    v_lshlrev_b32 v214, 3, v214
    v_and_b32 v209, 1, v211
    v_lshrrev_b32 v207, 1, v213
    v_lshl_or_b32 v207, v209, 1, v207
    v_lshl_add_u32 v215, v211, 3, v213
    v_lshl_add_u32 v215, v215, 7, v214
    s_lshl_b32 s59, s58, 1
    v_xor_b32 v208, s59, v207
    v_lshl_add_u32 v16, v208, 5, v215
    v_xor_b32 v17, 32, v16
    v_add_u32 v18, 0x10000, v16
    v_add_u32 v20, 0x20000, v16
    v_add_u32 v19, 0x10000, v17
    v_add_u32 v21, 0x20000, v17
    v_lshl_add_u32 v215, v211, 2, v213
    v_lshl_add_u32 v215, v215, 7, v214
    v_lshl_add_u32 v215, v207, 5, v215
    v_add_u32 v220, s46, v215
    v_xor_b32 v221, 32, v220
    v_xor_b32 v222, 64, v220
    v_xor_b32 v223, 96, v220
    v_add_u32 v224, 0x10000, v220
    v_add_u32 v228, 0x20000, v220
    v_add_u32 v225, 0x10000, v221
    v_add_u32 v229, 0x20000, v221
    v_add_u32 v226, 0x10000, v222
    v_add_u32 v230, 0x20000, v222
    v_add_u32 v227, 0x10000, v223
    v_add_u32 v231, 0x20000, v223
    v_mul_u32_u24 v199, 896, v210
    v_lshl_add_u32 v199, v209, 5, v199
    v_lshrrev_b32 v208, 1, v211
    v_lshl_add_u32 v199, v208, 4, v199
    s_lshl_b32 s60, s43, 2
    s_add_u32 s60, s60, s42
    s_mul_i32 s60, s60, 14336
    s_lshl_b32 s59, s44, 7
    s_add_u32 s8, s60, s59
    v_add_u32 v216, s46, v22
    v_xor_b32 v217, 4096, v216
    v_xor_b32 v218, 8192, v216
    v_xor_b32 v219, 12288, v216
    buffer_load_dwordx4 v4, s[20:23], s65 offen offset:2048 lds
    buffer_load_dwordx4 v5, s[20:23], s65 offen offset:3072 lds
    s_add_u32 m0, s46, 0xc000
    s_nop 0
    buffer_load_dwordx4 v6, s[24:27], s72 offen lds
    buffer_load_dwordx4 v7, s[24:27], s72 offen offset:1024 lds
    buffer_load_dwordx4 v8, s[24:27], s72 offen offset:2048 lds
    buffer_load_dwordx4 v9, s[24:27], s72 offen offset:3072 lds
    s_add_u32 m0, s46, 0x10000
    s_nop 0
    buffer_load_dwordx4 v2, s[20:23], s66 offen lds
    buffer_load_dwordx4 v3, s[20:23], s66 offen offset:1024 lds
    s_waitcnt vmcnt(10)
    s_barrier
    ds_read_b64_tr_b16 v[32:33], v16 offset:16384
    ds_read_b64_tr_b16 v[34:35], v16 offset:16896
    ds_read_b128 a[0:3], v10 offset:0
    ds_read_b128 a[4:7], v10 offset:2048
    ds_read_b128 a[8:11], v10 offset:4096
    ds_read_b128 a[12:15], v10 offset:6144
    ds_read_b64_tr_b16 v[36:37], v16 offset:24576
    ds_read_b64_tr_b16 v[38:39], v16 offset:25088
    ds_read_b64_tr_b16 v[40:41], v17 offset:16384
    ds_read_b64_tr_b16 v[42:43], v17 offset:16896
    ds_read_b64_tr_b16 v[44:45], v17 offset:24576
    ds_read_b64_tr_b16 v[46:47], v17 offset:25088
    buffer_load_dwordx4 v4, s[20:23], s66 offen offset:2048 lds
    buffer_load_dwordx4 v5, s[20:23], s66 offen offset:3072 lds
    s_waitcnt lgkmcnt(4)
    v_mfma_f32_16x16x32_bf16 v[64:67], v[32:35], a[0:3], 0
    ds_read_b64_tr_b16 v[48:49], v16 offset:20480
    v_mfma_f32_16x16x32_bf16 v[68:71], v[32:35], a[4:7], 0
    ds_read_b64_tr_b16 v[50:51], v16 offset:20992
    v_mfma_f32_16x16x32_bf16 v[72:75], v[32:35], a[8:11], 0
    ds_read_b128 a[16:19], v11 offset:0
    s_add_u32 m0, s46, 0x14000
    v_mfma_f32_16x16x32_bf16 v[76:79], v[32:35], a[12:15], 0
    ds_read_b128 a[20:23], v11 offset:2048
    buffer_load_dwordx4 v6, s[24:27], s73 offen lds
    v_mfma_f32_16x16x32_bf16 v[80:83], v[36:39], a[0:3], 0
    ds_read_b128 a[24:27], v11 offset:4096
    v_mfma_f32_16x16x32_bf16 v[84:87], v[36:39], a[4:7], 0
    ds_read_b128 a[28:31], v11 offset:6144
    v_mfma_f32_16x16x32_bf16 v[88:91], v[36:39], a[8:11], 0
    ds_read_b64_tr_b16 v[52:53], v16 offset:28672
    v_mfma_f32_16x16x32_bf16 v[92:95], v[36:39], a[12:15], 0
    s_waitcnt lgkmcnt(7)
    v_mfma_f32_16x16x32_bf16 v[96:99], v[40:43], a[0:3], 0
    ds_read_b64_tr_b16 v[54:55], v16 offset:29184
    v_mfma_f32_16x16x32_bf16 v[100:103], v[40:43], a[4:7], 0
    ds_read_b64_tr_b16 v[56:57], v17 offset:20480
    buffer_load_dwordx4 v7, s[24:27], s73 offen offset:1024 lds
    v_mfma_f32_16x16x32_bf16 v[104:107], v[40:43], a[8:11], 0
    ds_read_b64_tr_b16 v[58:59], v17 offset:20992
    v_mfma_f32_16x16x32_bf16 v[108:111], v[40:43], a[12:15], 0
    ds_read_b64_tr_b16 v[60:61], v17 offset:28672
    v_mfma_f32_16x16x32_bf16 v[112:115], v[44:47], a[0:3], 0
    ds_read_b64_tr_b16 v[62:63], v17 offset:29184
    v_mfma_f32_16x16x32_bf16 v[116:119], v[44:47], a[4:7], 0
    v_mfma_f32_16x16x32_bf16 v[120:123], v[44:47], a[8:11], 0
    buffer_load_dwordx4 v8, s[24:27], s73 offen offset:2048 lds
    v_mfma_f32_16x16x32_bf16 v[124:127], v[44:47], a[12:15], 0
    s_waitcnt vmcnt(7) lgkmcnt(4)
    s_barrier
    v_mfma_f32_16x16x32_bf16 v[64:67], v[48:51], a[16:19], v[64:67]
    ds_read_b64_tr_b16 v[32:33], v16 offset:49152
    v_mfma_f32_16x16x32_bf16 v[68:71], v[48:51], a[20:23], v[68:71]
    ds_read_b64_tr_b16 v[34:35], v16 offset:49664
    v_mfma_f32_16x16x32_bf16 v[72:75], v[48:51], a[24:27], v[72:75]
    ds_read_b128 a[32:35], v10 offset:32768
    v_mfma_f32_16x16x32_bf16 v[76:79], v[48:51], a[28:31], v[76:79]
    ds_read_b128 a[36:39], v10 offset:34816
    buffer_load_dwordx4 v9, s[24:27], s73 offen offset:3072 lds
    v_mfma_f32_16x16x32_bf16 v[80:83], v[52:55], a[16:19], v[80:83]
    ds_read_b128 a[40:43], v10 offset:36864
    v_mfma_f32_16x16x32_bf16 v[84:87], v[52:55], a[20:23], v[84:87]
    ds_read_b128 a[44:47], v10 offset:38912
    v_mfma_f32_16x16x32_bf16 v[88:91], v[52:55], a[24:27], v[88:91]
    ds_read_b64_tr_b16 v[36:37], v16 offset:57344
    v_mfma_f32_16x16x32_bf16 v[92:95], v[52:55], a[28:31], v[92:95]
    s_waitcnt lgkmcnt(7)
    v_mfma_f32_16x16x32_bf16 v[96:99], v[56:59], a[16:19], v[96:99]
    ds_read_b64_tr_b16 v[38:39], v16 offset:57856
    s_add_u32 m0, s46, 0x18000
    v_mfma_f32_16x16x32_bf16 v[100:103], v[56:59], a[20:23], v[100:103]
    ds_read_b64_tr_b16 v[40:41], v17 offset:49152
    buffer_load_dwordx4 v2, s[20:23], s67 offen lds
    v_mfma_f32_16x16x32_bf16 v[104:107], v[56:59], a[24:27], v[104:107]
    ds_read_b64_tr_b16 v[42:43], v17 offset:49664
    v_mfma_f32_16x16x32_bf16 v[108:111], v[56:59], a[28:31], v[108:111]
    ds_read_b64_tr_b16 v[44:45], v17 offset:57344
    v_mfma_f32_16x16x32_bf16 v[112:115], v[60:63], a[16:19], v[112:115]
    ds_read_b64_tr_b16 v[46:47], v17 offset:57856
    v_mfma_f32_16x16x32_bf16 v[116:119], v[60:63], a[20:23], v[116:119]
    buffer_load_dwordx4 v3, s[20:23], s67 offen offset:1024 lds
    v_mfma_f32_16x16x32_bf16 v[120:123], v[60:63], a[24:27], v[120:123]
    buffer_load_dwordx4 v4, s[20:23], s67 offen offset:2048 lds
    v_mfma_f32_16x16x32_bf16 v[124:127], v[60:63], a[28:31], v[124:127]
    s_waitcnt lgkmcnt(4)
    v_mfma_f32_16x16x32_bf16 v[64:67], v[32:35], a[32:35], v[64:67]
    ds_read_b64_tr_b16 v[48:49], v16 offset:53248
    v_mfma_f32_16x16x32_bf16 v[68:71], v[32:35], a[36:39], v[68:71]
    ds_read_b64_tr_b16 v[50:51], v16 offset:53760
    v_mfma_f32_16x16x32_bf16 v[72:75], v[32:35], a[40:43], v[72:75]
    ds_read_b128 a[48:51], v11 offset:32768
    v_mfma_f32_16x16x32_bf16 v[76:79], v[32:35], a[44:47], v[76:79]
    ds_read_b128 a[52:55], v11 offset:34816
    buffer_load_dwordx4 v5, s[20:23], s67 offen offset:3072 lds
    v_mfma_f32_16x16x32_bf16 v[80:83], v[36:39], a[32:35], v[80:83]
    ds_read_b128 a[56:59], v11 offset:36864
    v_mfma_f32_16x16x32_bf16 v[84:87], v[36:39], a[36:39], v[84:87]
    ds_read_b128 a[60:63], v11 offset:38912
    v_mfma_f32_16x16x32_bf16 v[88:91], v[36:39], a[40:43], v[88:91]
    ds_read_b64_tr_b16 v[52:53], v16 offset:61440
    v_mfma_f32_16x16x32_bf16 v[92:95], v[36:39], a[44:47], v[92:95]
    s_waitcnt lgkmcnt(7)
    v_mfma_f32_16x16x32_bf16 v[96:99], v[40:43], a[32:35], v[96:99]
    ds_read_b64_tr_b16 v[54:55], v16 offset:61952
    s_add_u32 m0, s46, 0x1c000
    v_mfma_f32_16x16x32_bf16 v[100:103], v[40:43], a[36:39], v[100:103]
    ds_read_b64_tr_b16 v[56:57], v17 offset:53248
    buffer_load_dwordx4 v6, s[24:27], s74 offen lds
    v_mfma_f32_16x16x32_bf16 v[104:107], v[40:43], a[40:43], v[104:107]
    ds_read_b64_tr_b16 v[58:59], v17 offset:53760
    v_mfma_f32_16x16x32_bf16 v[108:111], v[40:43], a[44:47], v[108:111]
    ds_read_b64_tr_b16 v[60:61], v17 offset:61440
    v_mfma_f32_16x16x32_bf16 v[112:115], v[44:47], a[32:35], v[112:115]
    ds_read_b64_tr_b16 v[62:63], v17 offset:61952
    v_mfma_f32_16x16x32_bf16 v[116:119], v[44:47], a[36:39], v[116:119]
    v_mfma_f32_16x16x32_bf16 v[120:123], v[44:47], a[40:43], v[120:123]
    buffer_load_dwordx4 v7, s[24:27], s74 offen offset:1024 lds
    v_mfma_f32_16x16x32_bf16 v[124:127], v[44:47], a[44:47], v[124:127]
    s_waitcnt vmcnt(6) lgkmcnt(4)
    s_barrier
    v_mfma_f32_16x16x32_bf16 v[64:67], v[48:51], a[48:51], v[64:67]
    ds_read_b64_tr_b16 v[32:33], v18 offset:16384
    v_mfma_f32_16x16x32_bf16 v[68:71], v[48:51], a[52:55], v[68:71]
    ds_read_b64_tr_b16 v[34:35], v18 offset:16896
    v_mfma_f32_16x16x32_bf16 v[72:75], v[48:51], a[56:59], v[72:75]
    ds_read_b128 a[64:67], v12 offset:0
    v_mfma_f32_16x16x32_bf16 v[76:79], v[48:51], a[60:63], v[76:79]
    ds_read_b128 a[68:71], v12 offset:2048
    buffer_load_dwordx4 v8, s[24:27], s74 offen offset:2048 lds
    v_mfma_f32_16x16x32_bf16 v[80:83], v[52:55], a[48:51], v[80:83]
    ds_read_b128 a[72:75], v12 offset:4096
    v_mfma_f32_16x16x32_bf16 v[84:87], v[52:55], a[52:55], v[84:87]
    ds_read_b128 a[76:79], v12 offset:6144
    v_mfma_f32_16x16x32_bf16 v[88:91], v[52:55], a[56:59], v[88:91]
    ds_read_b64_tr_b16 v[36:37], v18 offset:24576
    v_mfma_f32_16x16x32_bf16 v[92:95], v[52:55], a[60:63], v[92:95]
    s_waitcnt lgkmcnt(7)
    v_mfma_f32_16x16x32_bf16 v[96:99], v[56:59], a[48:51], v[96:99]
    ds_read_b64_tr_b16 v[38:39], v18 offset:25088
    v_mfma_f32_16x16x32_bf16 v[100:103], v[56:59], a[52:55], v[100:103]
    ds_read_b64_tr_b16 v[40:41], v19 offset:16384
    buffer_load_dwordx4 v9, s[24:27], s74 offen offset:3072 lds
    v_mfma_f32_16x16x32_bf16 v[104:107], v[56:59], a[56:59], v[104:107]
    ds_read_b64_tr_b16 v[42:43], v19 offset:16896
    v_mfma_f32_16x16x32_bf16 v[108:111], v[56:59], a[60:63], v[108:111]
    ds_read_b64_tr_b16 v[44:45], v19 offset:24576
    v_mfma_f32_16x16x32_bf16 v[112:115], v[60:63], a[48:51], v[112:115]
    ds_read_b64_tr_b16 v[46:47], v19 offset:25088
    s_add_u32 m0, s46, 0x20000
    v_mfma_f32_16x16x32_bf16 v[116:119], v[60:63], a[52:55], v[116:119]
    buffer_load_dwordx4 v232, s[24:27], s71 offen lds
    v_mfma_f32_16x16x32_bf16 v[120:123], v[60:63], a[56:59], v[120:123]
    buffer_load_dwordx4 v233, s[24:27], s71 offen offset:1024 lds
    v_mfma_f32_16x16x32_bf16 v[124:127], v[60:63], a[60:63], v[124:127]
    s_waitcnt lgkmcnt(4)
    v_mfma_f32_16x16x32_bf16 v[64:67], v[32:35], a[64:67], v[64:67]
    ds_read_b64_tr_b16 v[48:49], v18 offset:20480
    v_mfma_f32_16x16x32_bf16 v[68:71], v[32:35], a[68:71], v[68:71]
    ds_read_b64_tr_b16 v[50:51], v18 offset:20992
    v_mfma_f32_16x16x32_bf16 v[72:75], v[32:35], a[72:75], v[72:75]
    ds_read_b128 a[80:83], v13 offset:0
    v_mfma_f32_16x16x32_bf16 v[76:79], v[32:35], a[76:79], v[76:79]
    ds_read_b128 a[84:87], v13 offset:2048
    buffer_load_dwordx4 v234, s[24:27], s71 offen offset:2048 lds
    v_mfma_f32_16x16x32_bf16 v[80:83], v[36:39], a[64:67], v[80:83]
    ds_read_b128 a[88:91], v13 offset:4096
    v_mfma_f32_16x16x32_bf16 v[84:87], v[36:39], a[68:71], v[84:87]
    ds_read_b128 a[92:95], v13 offset:6144
    v_mfma_f32_16x16x32_bf16 v[88:91], v[36:39], a[72:75], v[88:91]
    ds_read_b64_tr_b16 v[52:53], v18 offset:28672
    v_mfma_f32_16x16x32_bf16 v[92:95], v[36:39], a[76:79], v[92:95]
    s_waitcnt lgkmcnt(7)
    v_mfma_f32_16x16x32_bf16 v[96:99], v[40:43], a[64:67], v[96:99]
    ds_read_b64_tr_b16 v[54:55], v18 offset:29184
    v_mfma_f32_16x16x32_bf16 v[100:103], v[40:43], a[68:71], v[100:103]
    ds_read_b64_tr_b16 v[56:57], v19 offset:20480
    buffer_load_dwordx4 v235, s[24:27], s71 offen offset:3072 lds
    v_mfma_f32_16x16x32_bf16 v[104:107], v[40:43], a[72:75], v[104:107]
    ds_read_b64_tr_b16 v[58:59], v19 offset:20992
    v_mfma_f32_16x16x32_bf16 v[108:111], v[40:43], a[76:79], v[108:111]
    ds_read_b64_tr_b16 v[60:61], v19 offset:28672
    v_mfma_f32_16x16x32_bf16 v[112:115], v[44:47], a[64:67], v[112:115]
    ds_read_b64_tr_b16 v[62:63], v19 offset:29184
    s_add_u32 m0, s46, 0x24000
    v_mfma_f32_16x16x32_bf16 v[116:119], v[44:47], a[68:71], v[116:119]
    buffer_load_dwordx4 v2, s[20:23], s68 offen lds
    v_mfma_f32_16x16x32_bf16 v[120:123], v[44:47], a[72:75], v[120:123]
    buffer_load_dwordx4 v3, s[20:23], s68 offen offset:1024 lds
    v_mfma_f32_16x16x32_bf16 v[124:127], v[44:47], a[76:79], v[124:127]
    s_waitcnt vmcnt(6) lgkmcnt(4)
    s_barrier
    v_mfma_f32_16x16x32_bf16 v[64:67], v[48:51], a[80:83], v[64:67]
    ds_read_b64_tr_b16 v[32:33], v18 offset:49152
    v_mfma_f32_16x16x32_bf16 v[68:71], v[48:51], a[84:87], v[68:71]
    ds_read_b64_tr_b16 v[34:35], v18 offset:49664
    v_mfma_f32_16x16x32_bf16 v[72:75], v[48:51], a[88:91], v[72:75]
    ds_read_b128 a[96:99], v12 offset:32768
    v_mfma_f32_16x16x32_bf16 v[76:79], v[48:51], a[92:95], v[76:79]
    ds_read_b128 a[100:103], v12 offset:34816
    buffer_load_dwordx4 v4, s[20:23], s68 offen offset:2048 lds
    v_mfma_f32_16x16x32_bf16 v[80:83], v[52:55], a[80:83], v[80:83]
    ds_read_b128 a[104:107], v12 offset:36864
    v_mfma_f32_16x16x32_bf16 v[84:87], v[52:55], a[84:87], v[84:87]
    ds_read_b128 a[108:111], v12 offset:38912
    v_mfma_f32_16x16x32_bf16 v[88:91], v[52:55], a[88:91], v[88:91]
    ds_read_b64_tr_b16 v[36:37], v18 offset:57344
    v_mfma_f32_16x16x32_bf16 v[92:95], v[52:55], a[92:95], v[92:95]
    s_waitcnt lgkmcnt(7)
    v_mfma_f32_16x16x32_bf16 v[96:99], v[56:59], a[80:83], v[96:99]
    ds_read_b64_tr_b16 v[38:39], v18 offset:57856
    v_mfma_f32_16x16x32_bf16 v[100:103], v[56:59], a[84:87], v[100:103]
    ds_read_b64_tr_b16 v[40:41], v19 offset:49152
    buffer_load_dwordx4 v5, s[20:23], s68 offen offset:3072 lds
    v_mfma_f32_16x16x32_bf16 v[104:107], v[56:59], a[88:91], v[104:107]
    ds_read_b64_tr_b16 v[42:43], v19 offset:49664
    v_mfma_f32_16x16x32_bf16 v[108:111], v[56:59], a[92:95], v[108:111]
    ds_read_b64_tr_b16 v[44:45], v19 offset:57344
    v_mfma_f32_16x16x32_bf16 v[112:115], v[60:63], a[80:83], v[112:115]
    ds_read_b64_tr_b16 v[46:47], v19 offset:57856
    v_mfma_f32_16x16x32_bf16 v[116:119], v[60:63], a[84:87], v[116:119]
    s_add_u32 m0, s46, 0x0
    v_mfma_f32_16x16x32_bf16 v[120:123], v[60:63], a[88:91], v[120:123]
    buffer_load_dwordx4 v6, s[24:27], s75 offen lds
    v_mfma_f32_16x16x32_bf16 v[124:127], v[60:63], a[92:95], v[124:127]
    s_waitcnt lgkmcnt(4)
    v_mfma_f32_16x16x32_bf16 v[64:67], v[32:35], a[96:99], v[64:67]
    ds_read_b64_tr_b16 v[48:49], v18 offset:53248
    v_mfma_f32_16x16x32_bf16 v[68:71], v[32:35], a[100:103], v[68:71]
    ds_read_b64_tr_b16 v[50:51], v18 offset:53760
    v_mfma_f32_16x16x32_bf16 v[72:75], v[32:35], a[104:107], v[72:75]
    ds_read_b128 a[112:115], v13 offset:32768
    v_mfma_f32_16x16x32_bf16 v[76:79], v[32:35], a[108:111], v[76:79]
    ds_read_b128 a[116:119], v13 offset:34816
    buffer_load_dwordx4 v7, s[24:27], s75 offen offset:1024 lds
    v_mfma_f32_16x16x32_bf16 v[80:83], v[36:39], a[96:99], v[80:83]
    ds_read_b128 a[120:123], v13 offset:36864
    v_mfma_f32_16x16x32_bf16 v[84:87], v[36:39], a[100:103], v[84:87]
    ds_read_b128 a[124:127], v13 offset:38912
    v_mfma_f32_16x16x32_bf16 v[88:91], v[36:39], a[104:107], v[88:91]
    ds_read_b64_tr_b16 v[52:53], v18 offset:61440
    v_mfma_f32_16x16x32_bf16 v[92:95], v[36:39], a[108:111], v[92:95]
    s_waitcnt lgkmcnt(7)
    v_mfma_f32_16x16x32_bf16 v[96:99], v[40:43], a[96:99], v[96:99]
    ds_read_b64_tr_b16 v[54:55], v18 offset:61952
    v_mfma_f32_16x16x32_bf16 v[100:103], v[40:43], a[100:103], v[100:103]
    ds_read_b64_tr_b16 v[56:57], v19 offset:53248
    buffer_load_dwordx4 v8, s[24:27], s75 offen offset:2048 lds
    v_mfma_f32_16x16x32_bf16 v[104:107], v[40:43], a[104:107], v[104:107]
    ds_read_b64_tr_b16 v[58:59], v19 offset:53760
    v_mfma_f32_16x16x32_bf16 v[108:111], v[40:43], a[108:111], v[108:111]
    ds_read_b64_tr_b16 v[60:61], v19 offset:61440
    v_mfma_f32_16x16x32_bf16 v[112:115], v[44:47], a[96:99], v[112:115]
    ds_read_b64_tr_b16 v[62:63], v19 offset:61952
    v_mfma_f32_16x16x32_bf16 v[116:119], v[44:47], a[100:103], v[116:119]
    buffer_load_dwordx4 v9, s[24:27], s75 offen offset:3072 lds
    v_mfma_f32_16x16x32_bf16 v[120:123], v[44:47], a[104:107], v[120:123]
    s_add_u32 m0, s46, 0x4000
    s_nop 0
    buffer_load_dwordx4 v2, s[20:23], s69 offen lds
    v_mfma_f32_16x16x32_bf16 v[124:127], v[44:47], a[108:111], v[124:127]
    s_waitcnt vmcnt(9) lgkmcnt(4)
    s_barrier
    v_mfma_f32_16x16x32_bf16 v[64:67], v[48:51], a[112:115], v[64:67]
    ds_read_b64_tr_b16 v[32:33], v20 offset:0
    v_mfma_f32_16x16x32_bf16 v[68:71], v[48:51], a[116:119], v[68:71]
    ds_read_b64_tr_b16 v[34:35], v20 offset:512
    v_mfma_f32_16x16x32_bf16 v[72:75], v[48:51], a[120:123], v[72:75]
    ds_read_b64_tr_b16 v[36:37], v20 offset:8192
    v_mfma_f32_16x16x32_bf16 v[76:79], v[48:51], a[124:127], v[76:79]
    ds_read_b64_tr_b16 v[38:39], v20 offset:8704
    v_mfma_f32_16x16x32_bf16 v[80:83], v[52:55], a[112:115], v[80:83]
    v_mfma_f32_16x16x32_bf16 v[84:87], v[52:55], a[116:119], v[84:87]
    buffer_load_dwordx4 v3, s[20:23], s69 offen offset:1024 lds
    v_mfma_f32_16x16x32_bf16 v[88:91], v[52:55], a[120:123], v[88:91]
    v_mfma_f32_16x16x32_bf16 v[92:95], v[52:55], a[124:127], v[92:95]
    s_waitcnt lgkmcnt(4)
    v_mfma_f32_16x16x32_bf16 v[96:99], v[56:59], a[112:115], v[96:99]
    ds_read_b64_tr_b16 v[40:41], v21 offset:0
    v_mfma_f32_16x16x32_bf16 v[100:103], v[56:59], a[116:119], v[100:103]
    ds_read_b64_tr_b16 v[42:43], v21 offset:512
    buffer_load_dwordx4 v4, s[20:23], s69 offen offset:2048 lds
    v_mfma_f32_16x16x32_bf16 v[104:107], v[56:59], a[120:123], v[104:107]
    ds_read_b64_tr_b16 v[44:45], v21 offset:8192
    v_mfma_f32_16x16x32_bf16 v[108:111], v[56:59], a[124:127], v[108:111]
    ds_read_b64_tr_b16 v[46:47], v21 offset:8704
    v_mfma_f32_16x16x32_bf16 v[112:115], v[60:63], a[112:115], v[112:115]
    v_mfma_f32_16x16x32_bf16 v[116:119], v[60:63], a[116:119], v[116:119]
    buffer_load_dwordx4 v5, s[20:23], s69 offen offset:3072 lds
    v_mfma_f32_16x16x32_bf16 v[120:123], v[60:63], a[120:123], v[120:123]
    v_mfma_f32_16x16x32_bf16 v[124:127], v[60:63], a[124:127], v[124:127]
    s_waitcnt lgkmcnt(4)
    v_mfma_f32_16x16x32_bf16 v[128:131], v[32:35], a[0:3], 0
    ds_read_b64_tr_b16 v[48:49], v20 offset:4096
    v_mfma_f32_16x16x32_bf16 v[132:135], v[32:35], a[4:7], 0
    ds_read_b64_tr_b16 v[50:51], v20 offset:4608
    s_add_u32 m0, s46, 0x8000
    v_mfma_f32_16x16x32_bf16 v[136:139], v[32:35], a[8:11], 0
    ds_read_b64_tr_b16 v[52:53], v20 offset:12288
    buffer_load_dwordx4 v6, s[24:27], s76 offen lds
    v_mfma_f32_16x16x32_bf16 v[140:143], v[32:35], a[12:15], 0
    ds_read_b64_tr_b16 v[54:55], v20 offset:12800
    v_mfma_f32_16x16x32_bf16 v[144:147], v[36:39], a[0:3], 0
    v_mfma_f32_16x16x32_bf16 v[148:151], v[36:39], a[4:7], 0
    v_mfma_f32_16x16x32_bf16 v[152:155], v[36:39], a[8:11], 0
    buffer_load_dwordx4 v7, s[24:27], s76 offen offset:1024 lds
    v_mfma_f32_16x16x32_bf16 v[156:159], v[36:39], a[12:15], 0
    s_waitcnt lgkmcnt(4)
    v_mfma_f32_16x16x32_bf16 v[160:163], v[40:43], a[0:3], 0
    ds_read_b64_tr_b16 v[56:57], v21 offset:4096
    v_mfma_f32_16x16x32_bf16 v[164:167], v[40:43], a[4:7], 0
    ds_read_b64_tr_b16 v[58:59], v21 offset:4608
    v_mfma_f32_16x16x32_bf16 v[168:171], v[40:43], a[8:11], 0
    ds_read_b64_tr_b16 v[60:61], v21 offset:12288
    buffer_load_dwordx4 v8, s[24:27], s76 offen offset:2048 lds
    v_mfma_f32_16x16x32_bf16 v[172:175], v[40:43], a[12:15], 0
    ds_read_b64_tr_b16 v[62:63], v21 offset:12800
    v_mfma_f32_16x16x32_bf16 v[176:179], v[44:47], a[0:3], 0
    v_mfma_f32_16x16x32_bf16 v[180:183], v[44:47], a[4:7], 0
    v_mfma_f32_16x16x32_bf16 v[184:187], v[44:47], a[8:11], 0
    buffer_load_dwordx4 v9, s[24:27], s76 offen offset:3072 lds
    v_mfma_f32_16x16x32_bf16 v[188:191], v[44:47], a[12:15], 0
    s_waitcnt vmcnt(8) lgkmcnt(4)
    s_barrier
    v_mfma_f32_16x16x32_bf16 v[128:131], v[48:51], a[16:19], v[128:131]
    ds_read_b64_tr_b16 v[32:33], v16 offset:0
    v_mfma_f32_16x16x32_bf16 v[132:135], v[48:51], a[20:23], v[132:135]
    ds_read_b64_tr_b16 v[34:35], v16 offset:512
    v_mfma_f32_16x16x32_bf16 v[136:139], v[48:51], a[24:27], v[136:139]
    ds_read_b128 a[128:131], v14 offset:16384
    s_add_u32 m0, s46, 0xc000
    v_mfma_f32_16x16x32_bf16 v[140:143], v[48:51], a[28:31], v[140:143]
    ds_read_b128 a[132:135], v14 offset:18432
    buffer_load_dwordx4 v2, s[20:23], s70 offen lds
    v_mfma_f32_16x16x32_bf16 v[144:147], v[52:55], a[16:19], v[144:147]
    ds_read_b128 a[136:139], v14 offset:20480
    v_mfma_f32_16x16x32_bf16 v[148:151], v[52:55], a[20:23], v[148:151]
    ds_read_b128 a[140:143], v14 offset:22528
    v_mfma_f32_16x16x32_bf16 v[152:155], v[52:55], a[24:27], v[152:155]
    ds_read_b64_tr_b16 v[36:37], v16 offset:8192
    v_mfma_f32_16x16x32_bf16 v[156:159], v[52:55], a[28:31], v[156:159]
    s_waitcnt lgkmcnt(7)
    v_mfma_f32_16x16x32_bf16 v[160:163], v[56:59], a[16:19], v[160:163]
    ds_read_b64_tr_b16 v[38:39], v16 offset:8704
    v_mfma_f32_16x16x32_bf16 v[164:167], v[56:59], a[20:23], v[164:167]
    ds_read_b64_tr_b16 v[40:41], v17 offset:0
    buffer_load_dwordx4 v3, s[20:23], s70 offen offset:1024 lds
    v_mfma_f32_16x16x32_bf16 v[168:171], v[56:59], a[24:27], v[168:171]
    ds_read_b64_tr_b16 v[42:43], v17 offset:512
    v_mfma_f32_16x16x32_bf16 v[172:175], v[56:59], a[28:31], v[172:175]
    ds_read_b64_tr_b16 v[44:45], v17 offset:8192
    v_mfma_f32_16x16x32_bf16 v[176:179], v[60:63], a[16:19], v[176:179]
    ds_read_b64_tr_b16 v[46:47], v17 offset:8704
    v_mfma_f32_16x16x32_bf16 v[180:183], v[60:63], a[20:23], v[180:183]
    buffer_load_dwordx4 v4, s[20:23], s70 offen offset:2048 lds
    v_mfma_f32_16x16x32_bf16 v[184:187], v[60:63], a[24:27], v[184:187]
    buffer_load_dwordx4 v5, s[20:23], s70 offen offset:3072 lds
    v_mfma_f32_16x16x32_bf16 v[188:191], v[60:63], a[28:31], v[188:191]
    s_waitcnt lgkmcnt(4)
    v_mfma_f32_16x16x32_bf16 v[64:67], v[32:35], a[128:131], v[64:67]
    ds_read_b64_tr_b16 v[48:49], v16 offset:4096
    v_mfma_f32_16x16x32_bf16 v[68:71], v[32:35], a[132:135], v[68:71]
    ds_read_b64_tr_b16 v[50:51], v16 offset:4608
    v_mfma_f32_16x16x32_bf16 v[72:75], v[32:35], a[136:139], v[72:75]
    ds_read_b128 a[144:147], v15 offset:16384
    s_add_u32 m0, s46, 0x10000
    v_mfma_f32_16x16x32_bf16 v[76:79], v[32:35], a[140:143], v[76:79]
    ds_read_b128 a[148:151], v15 offset:18432
    buffer_load_dwordx4 v6, s[24:27], s77 offen lds
    v_mfma_f32_16x16x32_bf16 v[80:83], v[36:39], a[128:131], v[80:83]
    ds_read_b128 a[152:155], v15 offset:20480
    v_mfma_f32_16x16x32_bf16 v[84:87], v[36:39], a[132:135], v[84:87]
    ds_read_b128 a[156:159], v15 offset:22528
    v_mfma_f32_16x16x32_bf16 v[88:91], v[36:39], a[136:139], v[88:91]
    ds_read_b64_tr_b16 v[52:53], v16 offset:12288
    v_mfma_f32_16x16x32_bf16 v[92:95], v[36:39], a[140:143], v[92:95]
    s_waitcnt lgkmcnt(7)
    v_mfma_f32_16x16x32_bf16 v[96:99], v[40:43], a[128:131], v[96:99]
    ds_read_b64_tr_b16 v[54:55], v16 offset:12800
    v_mfma_f32_16x16x32_bf16 v[100:103], v[40:43], a[132:135], v[100:103]
    ds_read_b64_tr_b16 v[56:57], v17 offset:4096
    buffer_load_dwordx4 v7, s[24:27], s77 offen offset:1024 lds
    v_mfma_f32_16x16x32_bf16 v[104:107], v[40:43], a[136:139], v[104:107]
    ds_read_b64_tr_b16 v[58:59], v17 offset:4608
    v_mfma_f32_16x16x32_bf16 v[108:111], v[40:43], a[140:143], v[108:111]
    ds_read_b64_tr_b16 v[60:61], v17 offset:12288
    v_mfma_f32_16x16x32_bf16 v[112:115], v[44:47], a[128:131], v[112:115]
    ds_read_b64_tr_b16 v[62:63], v17 offset:12800
    v_mfma_f32_16x16x32_bf16 v[116:119], v[44:47], a[132:135], v[116:119]
    v_mfma_f32_16x16x32_bf16 v[120:123], v[44:47], a[136:139], v[120:123]
    buffer_load_dwordx4 v8, s[24:27], s77 offen offset:2048 lds
    v_mfma_f32_16x16x32_bf16 v[124:127], v[44:47], a[140:143], v[124:127]
    s_waitcnt vmcnt(7) lgkmcnt(4)
    s_barrier
    v_mfma_f32_16x16x32_bf16 v[64:67], v[48:51], a[144:147], v[64:67]
    ds_read_b64_tr_b16 v[32:33], v16 offset:32768
    v_mfma_f32_16x16x32_bf16 v[68:71], v[48:51], a[148:151], v[68:71]
    ds_read_b64_tr_b16 v[34:35], v16 offset:33280
    v_mfma_f32_16x16x32_bf16 v[72:75], v[48:51], a[152:155], v[72:75]
    ds_read_b128 a[160:163], v10 offset:16384
    v_mfma_f32_16x16x32_bf16 v[76:79], v[48:51], a[156:159], v[76:79]
    ds_read_b128 a[164:167], v10 offset:18432
    buffer_load_dwordx4 v9, s[24:27], s77 offen offset:3072 lds
    v_mfma_f32_16x16x32_bf16 v[80:83], v[52:55], a[144:147], v[80:83]
    ds_read_b128 a[168:171], v10 offset:20480
    v_mfma_f32_16x16x32_bf16 v[84:87], v[52:55], a[148:151], v[84:87]
    ds_read_b128 a[172:175], v10 offset:22528
    v_mfma_f32_16x16x32_bf16 v[88:91], v[52:55], a[152:155], v[88:91]
    ds_read_b64_tr_b16 v[36:37], v16 offset:40960
    v_mfma_f32_16x16x32_bf16 v[92:95], v[52:55], a[156:159], v[92:95]
    s_waitcnt lgkmcnt(7)
    v_mfma_f32_16x16x32_bf16 v[96:99], v[56:59], a[144:147], v[96:99]
    ds_read_b64_tr_b16 v[38:39], v16 offset:41472
    s_add_u32 m0, s46, 0x14000
    v_mfma_f32_16x16x32_bf16 v[100:103], v[56:59], a[148:151], v[100:103]
    ds_read_b64_tr_b16 v[40:41], v17 offset:32768
    buffer_load_dwordx4 v232, s[24:27], s72 offen lds
    v_mfma_f32_16x16x32_bf16 v[104:107], v[56:59], a[152:155], v[104:107]
    ds_read_b64_tr_b16 v[42:43], v17 offset:33280
    v_mfma_f32_16x16x32_bf16 v[108:111], v[56:59], a[156:159], v[108:111]
    ds_read_b64_tr_b16 v[44:45], v17 offset:40960
    v_mfma_f32_16x16x32_bf16 v[112:115], v[60:63], a[144:147], v[112:115]
    ds_read_b64_tr_b16 v[46:47], v17 offset:41472
    v_mfma_f32_16x16x32_bf16 v[116:119], v[60:63], a[148:151], v[116:119]
    buffer_load_dwordx4 v233, s[24:27], s72 offen offset:1024 lds
    v_mfma_f32_16x16x32_bf16 v[120:123], v[60:63], a[152:155], v[120:123]
    buffer_load_dwordx4 v234, s[24:27], s72 offen offset:2048 lds
    v_mfma_f32_16x16x32_bf16 v[124:127], v[60:63], a[156:159], v[124:127]
    s_waitcnt lgkmcnt(4)
    v_mfma_f32_16x16x32_bf16 v[64:67], v[32:35], a[160:163], v[64:67]
    ds_read_b64_tr_b16 v[48:49], v16 offset:36864
    v_mfma_f32_16x16x32_bf16 v[68:71], v[32:35], a[164:167], v[68:71]
    ds_read_b64_tr_b16 v[50:51], v16 offset:37376
    v_mfma_f32_16x16x32_bf16 v[72:75], v[32:35], a[168:171], v[72:75]
    ds_read_b128 a[176:179], v11 offset:16384
    v_mfma_f32_16x16x32_bf16 v[76:79], v[32:35], a[172:175], v[76:79]
    ds_read_b128 a[180:183], v11 offset:18432
    buffer_load_dwordx4 v235, s[24:27], s72 offen offset:3072 lds
    v_mfma_f32_16x16x32_bf16 v[80:83], v[36:39], a[160:163], v[80:83]
    ds_read_b128 a[184:187], v11 offset:20480
    v_mfma_f32_16x16x32_bf16 v[84:87], v[36:39], a[164:167], v[84:87]
    ds_read_b128 a[188:191], v11 offset:22528
    v_mfma_f32_16x16x32_bf16 v[88:91], v[36:39], a[168:171], v[88:91]
    ds_read_b64_tr_b16 v[52:53], v16 offset:45056
    v_mfma_f32_16x16x32_bf16 v[92:95], v[36:39], a[172:175], v[92:95]
    s_waitcnt lgkmcnt(7)
    v_mfma_f32_16x16x32_bf16 v[96:99], v[40:43], a[160:163], v[96:99]
    ds_read_b64_tr_b16 v[54:55], v16 offset:45568
    s_add_u32 m0, s46, 0x18000
    v_mfma_f32_16x16x32_bf16 v[100:103], v[40:43], a[164:167], v[100:103]
    ds_read_b64_tr_b16 v[56:57], v17 offset:36864
    buffer_load_dwordx4 v232, s[24:27], s73 offen lds
    v_mfma_f32_16x16x32_bf16 v[104:107], v[40:43], a[168:171], v[104:107]
    ds_read_b64_tr_b16 v[58:59], v17 offset:37376
    v_mfma_f32_16x16x32_bf16 v[108:111], v[40:43], a[172:175], v[108:111]
    ds_read_b64_tr_b16 v[60:61], v17 offset:45056
    v_mfma_f32_16x16x32_bf16 v[112:115], v[44:47], a[160:163], v[112:115]
    ds_read_b64_tr_b16 v[62:63], v17 offset:45568
    v_mfma_f32_16x16x32_bf16 v[116:119], v[44:47], a[164:167], v[116:119]
    v_mfma_f32_16x16x32_bf16 v[120:123], v[44:47], a[168:171], v[120:123]
    buffer_load_dwordx4 v233, s[24:27], s73 offen offset:1024 lds
    v_mfma_f32_16x16x32_bf16 v[124:127], v[44:47], a[172:175], v[124:127]
    s_waitcnt vmcnt(6) lgkmcnt(4)
    s_barrier
    v_mfma_f32_16x16x32_bf16 v[64:67], v[48:51], a[176:179], v[64:67]
    ds_read_b64_tr_b16 v[32:33], v18 offset:0
    v_mfma_f32_16x16x32_bf16 v[68:71], v[48:51], a[180:183], v[68:71]
    ds_read_b64_tr_b16 v[34:35], v18 offset:512
    v_mfma_f32_16x16x32_bf16 v[72:75], v[48:51], a[184:187], v[72:75]
    ds_read_b128 a[192:195], v10 offset:49152
    v_mfma_f32_16x16x32_bf16 v[76:79], v[48:51], a[188:191], v[76:79]
    ds_read_b128 a[196:199], v10 offset:51200
    buffer_load_dwordx4 v234, s[24:27], s73 offen offset:2048 lds
    v_mfma_f32_16x16x32_bf16 v[80:83], v[52:55], a[176:179], v[80:83]
    ds_read_b128 a[200:203], v10 offset:53248
    v_mfma_f32_16x16x32_bf16 v[84:87], v[52:55], a[180:183], v[84:87]
    ds_read_b128 a[204:207], v10 offset:55296
    v_mfma_f32_16x16x32_bf16 v[88:91], v[52:55], a[184:187], v[88:91]
    ds_read_b64_tr_b16 v[36:37], v18 offset:8192
    v_mfma_f32_16x16x32_bf16 v[92:95], v[52:55], a[188:191], v[92:95]
    s_waitcnt lgkmcnt(7)
    v_mfma_f32_16x16x32_bf16 v[96:99], v[56:59], a[176:179], v[96:99]
    ds_read_b64_tr_b16 v[38:39], v18 offset:8704
    v_mfma_f32_16x16x32_bf16 v[100:103], v[56:59], a[180:183], v[100:103]
    ds_read_b64_tr_b16 v[40:41], v19 offset:0
    buffer_load_dwordx4 v235, s[24:27], s73 offen offset:3072 lds
    v_mfma_f32_16x16x32_bf16 v[104:107], v[56:59], a[184:187], v[104:107]
    ds_read_b64_tr_b16 v[42:43], v19 offset:512
    v_mfma_f32_16x16x32_bf16 v[108:111], v[56:59], a[188:191], v[108:111]
    ds_read_b64_tr_b16 v[44:45], v19 offset:8192
    v_mfma_f32_16x16x32_bf16 v[112:115], v[60:63], a[176:179], v[112:115]
    ds_read_b64_tr_b16 v[46:47], v19 offset:8704
    s_add_u32 m0, s46, 0x1c000
    v_mfma_f32_16x16x32_bf16 v[116:119], v[60:63], a[180:183], v[116:119]
    buffer_load_dwordx4 v232, s[24:27], s74 offen lds
    v_mfma_f32_16x16x32_bf16 v[120:123], v[60:63], a[184:187], v[120:123]
    buffer_load_dwordx4 v233, s[24:27], s74 offen offset:1024 lds
    v_mfma_f32_16x16x32_bf16 v[124:127], v[60:63], a[188:191], v[124:127]
    s_waitcnt lgkmcnt(4)
    s_cmp_lg_u32 s42, 1
    s_cbranch_scc1 L_nal
    global_load_dword v198, v197, s[14:15] sc1
L_nal:
    v_mfma_f32_16x16x32_bf16 v[64:67], v[32:35], a[192:195], v[64:67]
    ds_read_b64_tr_b16 v[48:49], v18 offset:4096
    v_mfma_f32_16x16x32_bf16 v[68:71], v[32:35], a[196:199], v[68:71]
    ds_read_b64_tr_b16 v[50:51], v18 offset:4608
    v_mfma_f32_16x16x32_bf16 v[72:75], v[32:35], a[200:203], v[72:75]
    ds_read_b128 a[208:211], v11 offset:49152
    v_mfma_f32_16x16x32_bf16 v[76:79], v[32:35], a[204:207], v[76:79]
    ds_read_b128 a[212:215], v11 offset:51200
    buffer_load_dwordx4 v234, s[24:27], s74 offen offset:2048 lds
    v_mfma_f32_16x16x32_bf16 v[80:83], v[36:39], a[192:195], v[80:83]
    ds_read_b128 a[216:219], v11 offset:53248
    v_mfma_f32_16x16x32_bf16 v[84:87], v[36:39], a[196:199], v[84:87]
    ds_read_b128 a[220:223], v11 offset:55296
    v_mfma_f32_16x16x32_bf16 v[88:91], v[36:39], a[200:203], v[88:91]
    ds_read_b64_tr_b16 v[52:53], v18 offset:12288
    v_mfma_f32_16x16x32_bf16 v[92:95], v[36:39], a[204:207], v[92:95]
    s_waitcnt lgkmcnt(7)
    v_mfma_f32_16x16x32_bf16 v[96:99], v[40:43], a[192:195], v[96:99]
    ds_read_b64_tr_b16 v[54:55], v18 offset:12800
    v_mfma_f32_16x16x32_bf16 v[100:103], v[40:43], a[196:199], v[100:103]
    ds_read_b64_tr_b16 v[56:57], v19 offset:4096
    buffer_load_dwordx4 v235, s[24:27], s74 offen offset:3072 lds
    v_mfma_f32_16x16x32_bf16 v[104:107], v[40:43], a[200:203], v[104:107]
    ds_read_b64_tr_b16 v[58:59], v19 offset:4608
    v_mfma_f32_16x16x32_bf16 v[108:111], v[40:43], a[204:207], v[108:111]
    ds_read_b64_tr_b16 v[60:61], v19 offset:12288
    v_mfma_f32_16x16x32_bf16 v[112:115], v[44:47], a[192:195], v[112:115]
    ds_read_b64_tr_b16 v[62:63], v19 offset:12800
    s_add_u32 m0, s46, 0x20000
    v_mfma_f32_16x16x32_bf16 v[116:119], v[44:47], a[196:199], v[116:119]
    buffer_load_dwordx4 v232, s[24:27], s75 offen lds
    v_mfma_f32_16x16x32_bf16 v[120:123], v[44:47], a[200:203], v[120:123]
    buffer_load_dwordx4 v233, s[24:27], s75 offen offset:1024 lds
    v_mfma_f32_16x16x32_bf16 v[124:127], v[44:47], a[204:207], v[124:127]
    s_waitcnt vmcnt(10) lgkmcnt(4)
    s_barrier
    v_mfma_f32_16x16x32_bf16 v[64:67], v[48:51], a[208:211], v[64:67]
    ds_read_b64_tr_b16 v[32:33], v18 offset:16384
    v_mfma_f32_16x16x32_bf16 v[68:71], v[48:51], a[212:215], v[68:71]
    ds_read_b64_tr_b16 v[34:35], v18 offset:16896
    v_mfma_f32_16x16x32_bf16 v[72:75], v[48:51], a[216:219], v[72:75]
    ds_read_b64_tr_b16 v[36:37], v18 offset:24576
    v_mfma_f32_16x16x32_bf16 v[76:79], v[48:51], a[220:223], v[76:79]
    ds_read_b64_tr_b16 v[38:39], v18 offset:25088
    v_mfma_f32_16x16x32_bf16 v[80:83], v[52:55], a[208:211], v[80:83]
    v_mfma_f32_16x16x32_bf16 v[84:87], v[52:55], a[212:215], v[84:87]
    buffer_load_dwordx4 v234, s[24:27], s75 offen offset:2048 lds
    v_mfma_f32_16x16x32_bf16 v[88:91], v[52:55], a[216:219], v[88:91]
    v_mfma_f32_16x16x32_bf16 v[92:95], v[52:55], a[220:223], v[92:95]
    s_waitcnt lgkmcnt(4)
    v_mfma_f32_16x16x32_bf16 v[96:99], v[56:59], a[208:211], v[96:99]
    ds_read_b64_tr_b16 v[40:41], v19 offset:16384
    v_mfma_f32_16x16x32_bf16 v[100:103], v[56:59], a[212:215], v[100:103]
    ds_read_b64_tr_b16 v[42:43], v19 offset:16896
    buffer_load_dwordx4 v235, s[24:27], s75 offen offset:3072 lds
    v_mfma_f32_16x16x32_bf16 v[104:107], v[56:59], a[216:219], v[104:107]
    ds_read_b64_tr_b16 v[44:45], v19 offset:24576
    v_mfma_f32_16x16x32_bf16 v[108:111], v[56:59], a[220:223], v[108:111]
    ds_read_b64_tr_b16 v[46:47], v19 offset:25088
    v_mfma_f32_16x16x32_bf16 v[112:115], v[60:63], a[208:211], v[112:115]
    s_add_u32 m0, s46, 0x24000
    v_mfma_f32_16x16x32_bf16 v[116:119], v[60:63], a[212:215], v[116:119]
    buffer_load_dwordx4 v232, s[24:27], s76 offen lds
    v_mfma_f32_16x16x32_bf16 v[120:123], v[60:63], a[216:219], v[120:123]
    v_mfma_f32_16x16x32_bf16 v[124:127], v[60:63], a[220:223], v[124:127]
    s_nop 4
    v_pk_mul_f32 v[64:65], v[64:65], s[4:5]
    buffer_load_dwordx4 v233, s[24:27], s76 offen offset:1024 lds
    v_pk_mul_f32 v[66:67], v[66:67], s[4:5]
    v_pk_mul_f32 v[96:97], v[96:97], s[4:5]
    v_pk_mul_f32 v[98:99], v[98:99], s[4:5]
    v_exp_f32 v64, v64
    v_exp_f32 v65, v65
    v_exp_f32 v66, v66
    v_exp_f32 v67, v67
    v_exp_f32 v96, v96
    v_exp_f32 v97, v97
    v_exp_f32 v98, v98
    buffer_load_dwordx4 v234, s[24:27], s76 offen offset:2048 lds
    v_exp_f32 v99, v99
    v_pk_add_f32 v[64:65], v[64:65], s[6:7]
    v_pk_add_f32 v[66:67], v[66:67], s[6:7]
    v_pk_add_f32 v[96:97], v[96:97], s[6:7]
    v_pk_add_f32 v[98:99], v[98:99], s[6:7]
    v_rcp_f32 v64, v64
    v_rcp_f32 v65, v65
    v_rcp_f32 v66, v66
    v_rcp_f32 v67, v67
    v_rcp_f32 v96, v96
    buffer_load_dwordx4 v235, s[24:27], s76 offen offset:3072 lds
    v_rcp_f32 v97, v97
    v_rcp_f32 v98, v98
    v_rcp_f32 v99, v99
    v_pk_mul_f32 v[64:65], v[64:65], v[80:81]
    v_pk_mul_f32 v[66:67], v[66:67], v[82:83]
    v_pk_mul_f32 v[96:97], v[96:97], v[112:113]
    v_pk_mul_f32 v[98:99], v[98:99], v[114:115]
    v_cvt_pk_bf16_f32 v80, v64, v65
    v_cvt_pk_bf16_f32 v81, v66, v67
    v_cvt_pk_bf16_f32 v82, v96, v97
    s_add_u32 m0, s46, 0x0
    s_nop 0
    buffer_load_dwordx4 v232, s[24:27], s77 offen lds
    v_cvt_pk_bf16_f32 v83, v98, v99
    s_nop 0
    buffer_store_dwordx4 v[80:83], v22, s[32:35], s47 offen sc1
    v_pk_mul_f32 v[68:69], v[68:69], s[4:5]
    v_pk_mul_f32 v[70:71], v[70:71], s[4:5]
    v_pk_mul_f32 v[100:101], v[100:101], s[4:5]
    v_pk_mul_f32 v[102:103], v[102:103], s[4:5]
    v_exp_f32 v68, v68
    v_exp_f32 v69, v69
    v_exp_f32 v70, v70
    v_exp_f32 v71, v71
    buffer_load_dwordx4 v233, s[24:27], s77 offen offset:1024 lds
    v_exp_f32 v100, v100
    v_exp_f32 v101, v101
    v_exp_f32 v102, v102
    v_exp_f32 v103, v103
    v_pk_add_f32 v[68:69], v[68:69], s[6:7]
    v_pk_add_f32 v[70:71], v[70:71], s[6:7]
    v_pk_add_f32 v[100:101], v[100:101], s[6:7]
    v_pk_add_f32 v[102:103], v[102:103], s[6:7]
    v_rcp_f32 v68, v68
    v_rcp_f32 v69, v69
    buffer_load_dwordx4 v234, s[24:27], s77 offen offset:2048 lds
    v_rcp_f32 v70, v70
    v_rcp_f32 v71, v71
    v_rcp_f32 v100, v100
    v_rcp_f32 v101, v101
    v_rcp_f32 v102, v102
    v_rcp_f32 v103, v103
    v_pk_mul_f32 v[68:69], v[68:69], v[84:85]
    v_pk_mul_f32 v[70:71], v[70:71], v[86:87]
    v_pk_mul_f32 v[100:101], v[100:101], v[116:117]
    v_pk_mul_f32 v[102:103], v[102:103], v[118:119]
    buffer_load_dwordx4 v235, s[24:27], s77 offen offset:3072 lds
    v_cvt_pk_bf16_f32 v84, v68, v69
    v_cvt_pk_bf16_f32 v85, v70, v71
    v_cvt_pk_bf16_f32 v86, v100, v101
    v_cvt_pk_bf16_f32 v87, v102, v103
    s_add_u32 s47, s47, 0xe000
    buffer_store_dwordx4 v[84:87], v22, s[32:35], s47 offen sc1
    v_pk_mul_f32 v[72:73], v[72:73], s[4:5]
    v_pk_mul_f32 v[74:75], v[74:75], s[4:5]
    v_pk_mul_f32 v[104:105], v[104:105], s[4:5]
    v_pk_mul_f32 v[106:107], v[106:107], s[4:5]
    v_exp_f32 v72, v72
    s_add_u32 m0, s46, 0x4000
    s_add_u32 s45, s48, 0x0
    buffer_load_dwordx4 v192, s[28:31], s45 offen lds
    v_exp_f32 v73, v73
    v_exp_f32 v74, v74
    v_exp_f32 v75, v75
    v_exp_f32 v104, v104
    v_exp_f32 v105, v105
    v_exp_f32 v106, v106
    v_exp_f32 v107, v107
    v_pk_add_f32 v[72:73], v[72:73], s[6:7]
    v_pk_add_f32 v[74:75], v[74:75], s[6:7]
    v_pk_add_f32 v[104:105], v[104:105], s[6:7]
    buffer_load_dwordx4 v193, s[28:31], s45 offen offset:1024 lds
    v_pk_add_f32 v[106:107], v[106:107], s[6:7]
    v_rcp_f32 v72, v72
    v_rcp_f32 v73, v73
    v_rcp_f32 v74, v74
    v_rcp_f32 v75, v75
    v_rcp_f32 v104, v104
    v_rcp_f32 v105, v105
    v_rcp_f32 v106, v106
    v_rcp_f32 v107, v107
    v_pk_mul_f32 v[72:73], v[72:73], v[88:89]
    buffer_load_dwordx4 v194, s[28:31], s45 offen offset:2048 lds
    v_pk_mul_f32 v[74:75], v[74:75], v[90:91]
    v_pk_mul_f32 v[104:105], v[104:105], v[120:121]
    v_pk_mul_f32 v[106:107], v[106:107], v[122:123]
    v_cvt_pk_bf16_f32 v88, v72, v73
    v_cvt_pk_bf16_f32 v89, v74, v75
    v_cvt_pk_bf16_f32 v90, v104, v105
    v_cvt_pk_bf16_f32 v91, v106, v107
    s_add_u32 s47, s47, 0xe000
    buffer_store_dwordx4 v[88:91], v22, s[32:35], s47 offen sc1
    v_pk_mul_f32 v[76:77], v[76:77], s[4:5]
    v_pk_mul_f32 v[78:79], v[78:79], s[4:5]
    buffer_load_dwordx4 v195, s[28:31], s45 offen offset:3072 lds
    v_pk_mul_f32 v[108:109], v[108:109], s[4:5]
    v_pk_mul_f32 v[110:111], v[110:111], s[4:5]
    v_exp_f32 v76, v76
    v_exp_f32 v77, v77
    v_exp_f32 v78, v78
    v_exp_f32 v79, v79
    v_exp_f32 v108, v108
    v_exp_f32 v109, v109
    v_exp_f32 v110, v110
    v_exp_f32 v111, v111
    s_add_u32 m0, s46, 0x8000
    s_add_u32 s45, s48, 0x38000
    buffer_load_dwordx4 v192, s[28:31], s45 offen lds
    v_pk_add_f32 v[76:77], v[76:77], s[6:7]
    v_pk_add_f32 v[78:79], v[78:79], s[6:7]
    v_pk_add_f32 v[108:109], v[108:109], s[6:7]
    v_pk_add_f32 v[110:111], v[110:111], s[6:7]
    v_rcp_f32 v76, v76
    v_rcp_f32 v77, v77
    v_rcp_f32 v78, v78
    v_rcp_f32 v79, v79
    v_rcp_f32 v108, v108
    v_rcp_f32 v109, v109
    buffer_load_dwordx4 v193, s[28:31], s45 offen offset:1024 lds
    v_rcp_f32 v110, v110
    v_rcp_f32 v111, v111
    v_pk_mul_f32 v[76:77], v[76:77], v[92:93]
    v_pk_mul_f32 v[78:79], v[78:79], v[94:95]
    v_pk_mul_f32 v[108:109], v[108:109], v[124:125]
    v_pk_mul_f32 v[110:111], v[110:111], v[126:127]
    v_cvt_pk_bf16_f32 v92, v76, v77
    v_cvt_pk_bf16_f32 v93, v78, v79
    v_cvt_pk_bf16_f32 v94, v108, v109
    v_cvt_pk_bf16_f32 v95, v110, v111
    buffer_load_dwordx4 v194, s[28:31], s45 offen offset:2048 lds
    s_add_u32 s47, s47, 0xe000
    buffer_store_dwordx4 v[92:95], v22, s[32:35], s47 offen sc1
    s_waitcnt lgkmcnt(4)
    v_mfma_f32_16x16x32_bf16 v[128:131], v[32:35], a[32:35], v[128:131]
    ds_read_b64_tr_b16 v[48:49], v18 offset:20480
    v_mfma_f32_16x16x32_bf16 v[132:135], v[32:35], a[36:39], v[132:135]
    ds_read_b64_tr_b16 v[50:51], v18 offset:20992
    v_mfma_f32_16x16x32_bf16 v[136:139], v[32:35], a[40:43], v[136:139]
    ds_read_b64_tr_b16 v[52:53], v18 offset:28672
    v_mfma_f32_16x16x32_bf16 v[140:143], v[32:35], a[44:47], v[140:143]
    ds_read_b64_tr_b16 v[54:55], v18 offset:29184
    v_mfma_f32_16x16x32_bf16 v[144:147], v[36:39], a[32:35], v[144:147]
    v_mfma_f32_16x16x32_bf16 v[148:151], v[36:39], a[36:39], v[148:151]
    buffer_load_dwordx4 v195, s[28:31], s45 offen offset:3072 lds
    v_mfma_f32_16x16x32_bf16 v[152:155], v[36:39], a[40:43], v[152:155]
    v_mfma_f32_16x16x32_bf16 v[156:159], v[36:39], a[44:47], v[156:159]
    s_waitcnt lgkmcnt(4)
    v_mfma_f32_16x16x32_bf16 v[160:163], v[40:43], a[32:35], v[160:163]
    ds_read_b64_tr_b16 v[56:57], v19 offset:20480
    v_mfma_f32_16x16x32_bf16 v[164:167], v[40:43], a[36:39], v[164:167]
    ds_read_b64_tr_b16 v[58:59], v19 offset:20992
    v_mfma_f32_16x16x32_bf16 v[168:171], v[40:43], a[40:43], v[168:171]
    ds_read_b64_tr_b16 v[60:61], v19 offset:28672
    v_mfma_f32_16x16x32_bf16 v[172:175], v[40:43], a[44:47], v[172:175]
    ds_read_b64_tr_b16 v[62:63], v19 offset:29184
    v_mfma_f32_16x16x32_bf16 v[176:179], v[44:47], a[32:35], v[176:179]
    v_mfma_f32_16x16x32_bf16 v[180:183], v[44:47], a[36:39], v[180:183]
    v_mfma_f32_16x16x32_bf16 v[184:187], v[44:47], a[40:43], v[184:187]
    v_mfma_f32_16x16x32_bf16 v[188:191], v[44:47], a[44:47], v[188:191]
    s_waitcnt vmcnt(28) lgkmcnt(4)
    s_barrier
    v_mfma_f32_16x16x32_bf16 v[128:131], v[48:51], a[48:51], v[128:131]
    ds_read_b64_tr_b16 v[32:33], v18 offset:32768
    v_mfma_f32_16x16x32_bf16 v[132:135], v[48:51], a[52:55], v[132:135]
    ds_read_b64_tr_b16 v[34:35], v18 offset:33280
    v_mfma_f32_16x16x32_bf16 v[136:139], v[48:51], a[56:59], v[136:139]
    ds_read_b64_tr_b16 v[36:37], v18 offset:40960
    v_mfma_f32_16x16x32_bf16 v[140:143], v[48:51], a[60:63], v[140:143]
    ds_read_b64_tr_b16 v[38:39], v18 offset:41472
    v_mfma_f32_16x16x32_bf16 v[144:147], v[52:55], a[48:51], v[144:147]
    s_add_u32 m0, s46, 0xc000
    s_add_u32 s45, s48, 0x70000
    v_mfma_f32_16x16x32_bf16 v[148:151], v[52:55], a[52:55], v[148:151]
    buffer_load_dwordx4 v192, s[28:31], s45 offen lds
    v_mfma_f32_16x16x32_bf16 v[152:155], v[52:55], a[56:59], v[152:155]
    v_mfma_f32_16x16x32_bf16 v[156:159], v[52:55], a[60:63], v[156:159]
    s_waitcnt lgkmcnt(4)
    v_mfma_f32_16x16x32_bf16 v[160:163], v[56:59], a[48:51], v[160:163]
    ds_read_b64_tr_b16 v[40:41], v19 offset:32768
    v_mfma_f32_16x16x32_bf16 v[164:167], v[56:59], a[52:55], v[164:167]
    ds_read_b64_tr_b16 v[42:43], v19 offset:33280
    buffer_load_dwordx4 v193, s[28:31], s45 offen offset:1024 lds
    v_mfma_f32_16x16x32_bf16 v[168:171], v[56:59], a[56:59], v[168:171]
    ds_read_b64_tr_b16 v[44:45], v19 offset:40960
    v_mfma_f32_16x16x32_bf16 v[172:175], v[56:59], a[60:63], v[172:175]
    ds_read_b64_tr_b16 v[46:47], v19 offset:41472
    v_mfma_f32_16x16x32_bf16 v[176:179], v[60:63], a[48:51], v[176:179]
    v_mfma_f32_16x16x32_bf16 v[180:183], v[60:63], a[52:55], v[180:183]
    buffer_load_dwordx4 v194, s[28:31], s45 offen offset:2048 lds
    v_mfma_f32_16x16x32_bf16 v[184:187], v[60:63], a[56:59], v[184:187]
    v_mfma_f32_16x16x32_bf16 v[188:191], v[60:63], a[60:63], v[188:191]
    s_waitcnt lgkmcnt(4)
    v_mfma_f32_16x16x32_bf16 v[128:131], v[32:35], a[64:67], v[128:131]
    ds_read_b64_tr_b16 v[48:49], v18 offset:36864
    v_mfma_f32_16x16x32_bf16 v[132:135], v[32:35], a[68:71], v[132:135]
    ds_read_b64_tr_b16 v[50:51], v18 offset:37376
    v_mfma_f32_16x16x32_bf16 v[136:139], v[32:35], a[72:75], v[136:139]
    ds_read_b64_tr_b16 v[52:53], v18 offset:45056
    v_mfma_f32_16x16x32_bf16 v[140:143], v[32:35], a[76:79], v[140:143]
    ds_read_b64_tr_b16 v[54:55], v18 offset:45568
    v_mfma_f32_16x16x32_bf16 v[144:147], v[36:39], a[64:67], v[144:147]
    v_mfma_f32_16x16x32_bf16 v[148:151], v[36:39], a[68:71], v[148:151]
    buffer_load_dwordx4 v195, s[28:31], s45 offen offset:3072 lds
    v_mfma_f32_16x16x32_bf16 v[152:155], v[36:39], a[72:75], v[152:155]
    v_mfma_f32_16x16x32_bf16 v[156:159], v[36:39], a[76:79], v[156:159]
    s_waitcnt lgkmcnt(4)
    v_mfma_f32_16x16x32_bf16 v[160:163], v[40:43], a[64:67], v[160:163]
    ds_read_b64_tr_b16 v[56:57], v19 offset:36864
    s_add_u32 m0, s46, 0x10000
    s_add_u32 s45, s48, 0xa8000
    v_mfma_f32_16x16x32_bf16 v[164:167], v[40:43], a[68:71], v[164:167]
    ds_read_b64_tr_b16 v[58:59], v19 offset:37376
    buffer_load_dwordx4 v192, s[28:31], s45 offen lds
    v_mfma_f32_16x16x32_bf16 v[168:171], v[40:43], a[72:75], v[168:171]
    ds_read_b64_tr_b16 v[60:61], v19 offset:45056
    v_mfma_f32_16x16x32_bf16 v[172:175], v[40:43], a[76:79], v[172:175]
    ds_read_b64_tr_b16 v[62:63], v19 offset:45568
    v_mfma_f32_16x16x32_bf16 v[176:179], v[44:47], a[64:67], v[176:179]
    v_mfma_f32_16x16x32_bf16 v[180:183], v[44:47], a[68:71], v[180:183]
    buffer_load_dwordx4 v193, s[28:31], s45 offen offset:1024 lds
    v_mfma_f32_16x16x32_bf16 v[184:187], v[44:47], a[72:75], v[184:187]
    v_mfma_f32_16x16x32_bf16 v[188:191], v[44:47], a[76:79], v[188:191]
    s_waitcnt vmcnt(7) lgkmcnt(4)
    s_barrier
    s_cmp_lg_u32 s42, 1
    s_cbranch_scc1 L_nosig0
    s_mov_b32 s61, 0
L_arm:
    v_readfirstlane_b32 s57, v198
    s_addk_i32 s61, 1
    s_cmp_ge_u32 s61, 0x40000
    s_cbranch_scc1 L_armd
    s_cmp_ge_u32 s57, 32
    s_cbranch_scc1 L_armd
    s_sleep 8
    global_load_dword v198, v197, s[14:15] sc1
    s_waitcnt vmcnt(0)
    s_branch L_arm
L_armd:
    s_mov_b64 exec, 0x3fff
    global_store_dword v23, v201, s[16:17] offset:0 sc1
    s_mov_b64 exec, -1
L_nosig0:
    v_mfma_f32_16x16x32_bf16 v[128:131], v[48:51], a[80:83], v[128:131]
    ds_read_b64_tr_b16 v[32:33], v18 offset:49152
    v_mfma_f32_16x16x32_bf16 v[132:135], v[48:51], a[84:87], v[132:135]
    ds_read_b64_tr_b16 v[34:35], v18 offset:49664
    v_mfma_f32_16x16x32_bf16 v[136:139], v[48:51], a[88:91], v[136:139]
    ds_read_b64_tr_b16 v[36:37], v18 offset:57344
    v_mfma_f32_16x16x32_bf16 v[140:143], v[48:51], a[92:95], v[140:143]
    ds_read_b64_tr_b16 v[38:39], v18 offset:57856
    v_mfma_f32_16x16x32_bf16 v[144:147], v[52:55], a[80:83], v[144:147]
    v_mfma_f32_16x16x32_bf16 v[148:151], v[52:55], a[84:87], v[148:151]
    buffer_load_dwordx4 v194, s[28:31], s45 offen offset:2048 lds
    v_mfma_f32_16x16x32_bf16 v[152:155], v[52:55], a[88:91], v[152:155]
    v_mfma_f32_16x16x32_bf16 v[156:159], v[52:55], a[92:95], v[156:159]
    s_waitcnt lgkmcnt(4)
    v_mfma_f32_16x16x32_bf16 v[160:163], v[56:59], a[80:83], v[160:163]
    ds_read_b64_tr_b16 v[40:41], v19 offset:49152
    v_mfma_f32_16x16x32_bf16 v[164:167], v[56:59], a[84:87], v[164:167]
    ds_read_b64_tr_b16 v[42:43], v19 offset:49664
    buffer_load_dwordx4 v195, s[28:31], s45 offen offset:3072 lds
    v_mfma_f32_16x16x32_bf16 v[168:171], v[56:59], a[88:91], v[168:171]
    ds_read_b64_tr_b16 v[44:45], v19 offset:57344
    v_mfma_f32_16x16x32_bf16 v[172:175], v[56:59], a[92:95], v[172:175]
    ds_read_b64_tr_b16 v[46:47], v19 offset:57856
    v_mfma_f32_16x16x32_bf16 v[176:179], v[60:63], a[80:83], v[176:179]
    s_add_u32 m0, s46, 0x14000
    s_add_u32 s45, s48, 0xe0000
    v_mfma_f32_16x16x32_bf16 v[180:183], v[60:63], a[84:87], v[180:183]
    buffer_load_dwordx4 v192, s[28:31], s45 offen lds
    v_mfma_f32_16x16x32_bf16 v[184:187], v[60:63], a[88:91], v[184:187]
    v_mfma_f32_16x16x32_bf16 v[188:191], v[60:63], a[92:95], v[188:191]
    s_waitcnt lgkmcnt(4)
    v_mfma_f32_16x16x32_bf16 v[128:131], v[32:35], a[96:99], v[128:131]
    ds_read_b64_tr_b16 v[48:49], v18 offset:53248
    v_mfma_f32_16x16x32_bf16 v[132:135], v[32:35], a[100:103], v[132:135]
    ds_read_b64_tr_b16 v[50:51], v18 offset:53760
    v_mfma_f32_16x16x32_bf16 v[136:139], v[32:35], a[104:107], v[136:139]
    ds_read_b64_tr_b16 v[52:53], v18 offset:61440
    v_mfma_f32_16x16x32_bf16 v[140:143], v[32:35], a[108:111], v[140:143]
    ds_read_b64_tr_b16 v[54:55], v18 offset:61952
    v_mfma_f32_16x16x32_bf16 v[144:147], v[36:39], a[96:99], v[144:147]
    v_mfma_f32_16x16x32_bf16 v[148:151], v[36:39], a[100:103], v[148:151]
    buffer_load_dwordx4 v193, s[28:31], s45 offen offset:1024 lds
    v_mfma_f32_16x16x32_bf16 v[152:155], v[36:39], a[104:107], v[152:155]
    v_mfma_f32_16x16x32_bf16 v[156:159], v[36:39], a[108:111], v[156:159]
    s_waitcnt lgkmcnt(4)
    v_mfma_f32_16x16x32_bf16 v[160:163], v[40:43], a[96:99], v[160:163]
    ds_read_b64_tr_b16 v[56:57], v19 offset:53248
    v_mfma_f32_16x16x32_bf16 v[164:167], v[40:43], a[100:103], v[164:167]
    ds_read_b64_tr_b16 v[58:59], v19 offset:53760
    buffer_load_dwordx4 v194, s[28:31], s45 offen offset:2048 lds
    v_mfma_f32_16x16x32_bf16 v[168:171], v[40:43], a[104:107], v[168:171]
    ds_read_b64_tr_b16 v[60:61], v19 offset:61440
    v_mfma_f32_16x16x32_bf16 v[172:175], v[40:43], a[108:111], v[172:175]
    ds_read_b64_tr_b16 v[62:63], v19 offset:61952
    v_mfma_f32_16x16x32_bf16 v[176:179], v[44:47], a[96:99], v[176:179]
    v_mfma_f32_16x16x32_bf16 v[180:183], v[44:47], a[100:103], v[180:183]
    buffer_load_dwordx4 v195, s[28:31], s45 offen offset:3072 lds
    v_mfma_f32_16x16x32_bf16 v[184:187], v[44:47], a[104:107], v[184:187]
    v_mfma_f32_16x16x32_bf16 v[188:191], v[44:47], a[108:111], v[188:191]
    s_waitcnt vmcnt(32) lgkmcnt(4)
    s_barrier
    v_mfma_f32_16x16x32_bf16 v[128:131], v[48:51], a[112:115], v[128:131]
    ds_read_b64_tr_b16 v[32:33], v20 offset:0
    v_mfma_f32_16x16x32_bf16 v[132:135], v[48:51], a[116:119], v[132:135]
    ds_read_b64_tr_b16 v[34:35], v20 offset:512
    v_mfma_f32_16x16x32_bf16 v[136:139], v[48:51], a[120:123], v[136:139]
    ds_read_b64_tr_b16 v[36:37], v20 offset:8192
    v_mfma_f32_16x16x32_bf16 v[140:143], v[48:51], a[124:127], v[140:143]
    ds_read_b64_tr_b16 v[38:39], v20 offset:8704
    v_mfma_f32_16x16x32_bf16 v[144:147], v[52:55], a[112:115], v[144:147]
    s_add_u32 m0, s46, 0x18000
    s_add_u32 s45, s48, 0x118000
    v_mfma_f32_16x16x32_bf16 v[148:151], v[52:55], a[116:119], v[148:151]
    buffer_load_dwordx4 v192, s[28:31], s45 offen lds
    v_mfma_f32_16x16x32_bf16 v[152:155], v[52:55], a[120:123], v[152:155]
    v_mfma_f32_16x16x32_bf16 v[156:159], v[52:55], a[124:127], v[156:159]
    s_waitcnt lgkmcnt(4)
    v_mfma_f32_16x16x32_bf16 v[160:163], v[56:59], a[112:115], v[160:163]
    ds_read_b64_tr_b16 v[40:41], v21 offset:0
    v_mfma_f32_16x16x32_bf16 v[164:167], v[56:59], a[116:119], v[164:167]
    ds_read_b64_tr_b16 v[42:43], v21 offset:512
    buffer_load_dwordx4 v193, s[28:31], s45 offen offset:1024 lds
    v_mfma_f32_16x16x32_bf16 v[168:171], v[56:59], a[120:123], v[168:171]
    ds_read_b64_tr_b16 v[44:45], v21 offset:8192
    v_mfma_f32_16x16x32_bf16 v[172:175], v[56:59], a[124:127], v[172:175]
    ds_read_b64_tr_b16 v[46:47], v21 offset:8704
    v_mfma_f32_16x16x32_bf16 v[176:179], v[60:63], a[112:115], v[176:179]
    v_mfma_f32_16x16x32_bf16 v[180:183], v[60:63], a[116:119], v[180:183]
    buffer_load_dwordx4 v194, s[28:31], s45 offen offset:2048 lds
    v_mfma_f32_16x16x32_bf16 v[184:187], v[60:63], a[120:123], v[184:187]
    v_mfma_f32_16x16x32_bf16 v[188:191], v[60:63], a[124:127], v[188:191]
    s_waitcnt lgkmcnt(4)
    v_mfma_f32_16x16x32_bf16 v[128:131], v[32:35], a[128:131], v[128:131]
    ds_read_b64_tr_b16 v[48:49], v20 offset:4096
    v_mfma_f32_16x16x32_bf16 v[132:135], v[32:35], a[132:135], v[132:135]
    ds_read_b64_tr_b16 v[50:51], v20 offset:4608
    v_mfma_f32_16x16x32_bf16 v[136:139], v[32:35], a[136:139], v[136:139]
    ds_read_b64_tr_b16 v[52:53], v20 offset:12288
    v_mfma_f32_16x16x32_bf16 v[140:143], v[32:35], a[140:143], v[140:143]
    ds_read_b64_tr_b16 v[54:55], v20 offset:12800
    v_mfma_f32_16x16x32_bf16 v[144:147], v[36:39], a[128:131], v[144:147]
    v_mfma_f32_16x16x32_bf16 v[148:151], v[36:39], a[132:135], v[148:151]
    buffer_load_dwordx4 v195, s[28:31], s45 offen offset:3072 lds
    v_mfma_f32_16x16x32_bf16 v[152:155], v[36:39], a[136:139], v[152:155]
    v_mfma_f32_16x16x32_bf16 v[156:159], v[36:39], a[140:143], v[156:159]
    s_waitcnt lgkmcnt(4)
    v_mfma_f32_16x16x32_bf16 v[160:163], v[40:43], a[128:131], v[160:163]
    ds_read_b64_tr_b16 v[56:57], v21 offset:4096
    v_mfma_f32_16x16x32_bf16 v[164:167], v[40:43], a[132:135], v[164:167]
    ds_read_b64_tr_b16 v[58:59], v21 offset:4608
    v_mfma_f32_16x16x32_bf16 v[168:171], v[40:43], a[136:139], v[168:171]
    ds_read_b64_tr_b16 v[60:61], v21 offset:12288
    v_mfma_f32_16x16x32_bf16 v[172:175], v[40:43], a[140:143], v[172:175]
    ds_read_b64_tr_b16 v[62:63], v21 offset:12800
    v_mfma_f32_16x16x32_bf16 v[176:179], v[44:47], a[128:131], v[176:179]
    v_mfma_f32_16x16x32_bf16 v[180:183], v[44:47], a[132:135], v[180:183]
    v_mfma_f32_16x16x32_bf16 v[184:187], v[44:47], a[136:139], v[184:187]
    v_mfma_f32_16x16x32_bf16 v[188:191], v[44:47], a[140:143], v[188:191]
    s_waitcnt vmcnt(32) lgkmcnt(4)
    s_barrier
    v_mfma_f32_16x16x32_bf16 v[128:131], v[48:51], a[144:147], v[128:131]
    ds_read_b64_tr_b16 v[32:33], v20 offset:16384
    v_mfma_f32_16x16x32_bf16 v[132:135], v[48:51], a[148:151], v[132:135]
    ds_read_b64_tr_b16 v[34:35], v20 offset:16896
    v_mfma_f32_16x16x32_bf16 v[136:139], v[48:51], a[152:155], v[136:139]
    ds_read_b64_tr_b16 v[36:37], v20 offset:24576
    v_mfma_f32_16x16x32_bf16 v[140:143], v[48:51], a[156:159], v[140:143]
    ds_read_b64_tr_b16 v[38:39], v20 offset:25088
    v_mfma_f32_16x16x32_bf16 v[144:147], v[52:55], a[144:147], v[144:147]
    s_add_u32 m0, s46, 0x1c000
    s_add_u32 s45, s48, 0x150000
    v_mfma_f32_16x16x32_bf16 v[148:151], v[52:55], a[148:151], v[148:151]
    buffer_load_dwordx4 v192, s[28:31], s45 offen lds
    v_mfma_f32_16x16x32_bf16 v[152:155], v[52:55], a[152:155], v[152:155]
    v_mfma_f32_16x16x32_bf16 v[156:159], v[52:55], a[156:159], v[156:159]
    s_waitcnt lgkmcnt(4)
    s_cmp_lg_u32 s42, 1
    s_cbranch_scc1 L_npi0
    global_load_dword v200, v196, s[16:17] offset:0 sc1
L_npi0:
    v_mfma_f32_16x16x32_bf16 v[160:163], v[56:59], a[144:147], v[160:163]
    ds_read_b64_tr_b16 v[40:41], v21 offset:16384
    v_mfma_f32_16x16x32_bf16 v[164:167], v[56:59], a[148:151], v[164:167]
    ds_read_b64_tr_b16 v[42:43], v21 offset:16896
    buffer_load_dwordx4 v193, s[28:31], s45 offen offset:1024 lds
    v_mfma_f32_16x16x32_bf16 v[168:171], v[56:59], a[152:155], v[168:171]
    ds_read_b64_tr_b16 v[44:45], v21 offset:24576
    v_mfma_f32_16x16x32_bf16 v[172:175], v[56:59], a[156:159], v[172:175]
    ds_read_b64_tr_b16 v[46:47], v21 offset:25088
    v_mfma_f32_16x16x32_bf16 v[176:179], v[60:63], a[144:147], v[176:179]
    v_mfma_f32_16x16x32_bf16 v[180:183], v[60:63], a[148:151], v[180:183]
    buffer_load_dwordx4 v194, s[28:31], s45 offen offset:2048 lds
    v_mfma_f32_16x16x32_bf16 v[184:187], v[60:63], a[152:155], v[184:187]
    v_mfma_f32_16x16x32_bf16 v[188:191], v[60:63], a[156:159], v[188:191]
    s_waitcnt lgkmcnt(4)
    v_mfma_f32_16x16x32_bf16 v[128:131], v[32:35], a[160:163], v[128:131]
    ds_read_b64_tr_b16 v[48:49], v20 offset:20480
    v_mfma_f32_16x16x32_bf16 v[132:135], v[32:35], a[164:167], v[132:135]
    ds_read_b64_tr_b16 v[50:51], v20 offset:20992
    v_mfma_f32_16x16x32_bf16 v[136:139], v[32:35], a[168:171], v[136:139]
    ds_read_b64_tr_b16 v[52:53], v20 offset:28672
    v_mfma_f32_16x16x32_bf16 v[140:143], v[32:35], a[172:175], v[140:143]
    ds_read_b64_tr_b16 v[54:55], v20 offset:29184
    v_mfma_f32_16x16x32_bf16 v[144:147], v[36:39], a[160:163], v[144:147]
    v_mfma_f32_16x16x32_bf16 v[148:151], v[36:39], a[164:167], v[148:151]
    buffer_load_dwordx4 v195, s[28:31], s45 offen offset:3072 lds
    v_mfma_f32_16x16x32_bf16 v[152:155], v[36:39], a[168:171], v[152:155]
    v_mfma_f32_16x16x32_bf16 v[156:159], v[36:39], a[172:175], v[156:159]
    s_waitcnt lgkmcnt(4)
    v_mfma_f32_16x16x32_bf16 v[160:163], v[40:43], a[160:163], v[160:163]
    ds_read_b64_tr_b16 v[56:57], v21 offset:20480
    v_mfma_f32_16x16x32_bf16 v[164:167], v[40:43], a[164:167], v[164:167]
    ds_read_b64_tr_b16 v[58:59], v21 offset:20992
    v_mfma_f32_16x16x32_bf16 v[168:171], v[40:43], a[168:171], v[168:171]
    ds_read_b64_tr_b16 v[60:61], v21 offset:28672
    v_mfma_f32_16x16x32_bf16 v[172:175], v[40:43], a[172:175], v[172:175]
    ds_read_b64_tr_b16 v[62:63], v21 offset:29184
    v_mfma_f32_16x16x32_bf16 v[176:179], v[44:47], a[160:163], v[176:179]
    v_mfma_f32_16x16x32_bf16 v[180:183], v[44:47], a[164:167], v[180:183]
    v_mfma_f32_16x16x32_bf16 v[184:187], v[44:47], a[168:171], v[184:187]
    v_mfma_f32_16x16x32_bf16 v[188:191], v[44:47], a[172:175], v[188:191]
    s_waitcnt vmcnt(31) lgkmcnt(4)
    s_cmp_lg_u32 s42, 1
    s_cbranch_scc1 L_pok0
    s_waitcnt vmcnt(3)
    s_mov_b32 s61, 0
L_poll0:
    v_cmp_ne_u32 vcc, 1, v200
    s_addk_i32 s61, 1
    s_cmp_ge_u32 s61, 0x40000
    s_cbranch_scc1 L_pok0
    s_cmp_eq_u64 vcc, 0
    s_cbranch_scc1 L_pok0
    s_sleep 2
    global_load_dword v200, v196, s[16:17] offset:0 sc1
    s_waitcnt vmcnt(0)
    s_branch L_poll0
L_pok0:
    s_barrier
    v_mfma_f32_16x16x32_bf16 v[128:131], v[48:51], a[176:179], v[128:131]
    ds_read_b64_tr_b16 v[32:33], v16 offset:0
    v_mfma_f32_16x16x32_bf16 v[132:135], v[48:51], a[180:183], v[132:135]
    ds_read_b64_tr_b16 v[34:35], v16 offset:512
    v_mfma_f32_16x16x32_bf16 v[136:139], v[48:51], a[184:187], v[136:139]
    ds_read_b64_tr_b16 v[36:37], v16 offset:8192
    v_mfma_f32_16x16x32_bf16 v[140:143], v[48:51], a[188:191], v[140:143]
    ds_read_b64_tr_b16 v[38:39], v16 offset:8704
    v_mfma_f32_16x16x32_bf16 v[144:147], v[52:55], a[176:179], v[144:147]
    s_add_u32 m0, s46, 0x20000
    s_add_u32 s45, s48, 0xe000
    v_mfma_f32_16x16x32_bf16 v[148:151], v[52:55], a[180:183], v[148:151]
    s_mov_b32 s50, 0x0
    buffer_load_dwordx4 a[0:3], v24, s[32:35], s50 offen sc1
    v_mfma_f32_16x16x32_bf16 v[152:155], v[52:55], a[184:187], v[152:155]
    v_mfma_f32_16x16x32_bf16 v[156:159], v[52:55], a[188:191], v[156:159]
    s_waitcnt lgkmcnt(4)
    v_mfma_f32_16x16x32_bf16 v[160:163], v[56:59], a[176:179], v[160:163]
    ds_read_b64_tr_b16 v[40:41], v17 offset:0
    v_mfma_f32_16x16x32_bf16 v[164:167], v[56:59], a[180:183], v[164:167]
    ds_read_b64_tr_b16 v[42:43], v17 offset:512
    buffer_load_dwordx4 a[4:7], v25, s[32:35], s50 offen sc1
    v_mfma_f32_16x16x32_bf16 v[168:171], v[56:59], a[184:187], v[168:171]
    ds_read_b64_tr_b16 v[44:45], v17 offset:8192
    v_mfma_f32_16x16x32_bf16 v[172:175], v[56:59], a[188:191], v[172:175]
    ds_read_b64_tr_b16 v[46:47], v17 offset:8704
    v_mfma_f32_16x16x32_bf16 v[176:179], v[60:63], a[176:179], v[176:179]
    v_mfma_f32_16x16x32_bf16 v[180:183], v[60:63], a[180:183], v[180:183]
    buffer_load_dwordx4 a[8:11], v26, s[32:35], s50 offen sc1
    v_mfma_f32_16x16x32_bf16 v[184:187], v[60:63], a[184:187], v[184:187]
    v_mfma_f32_16x16x32_bf16 v[188:191], v[60:63], a[188:191], v[188:191]
    s_waitcnt lgkmcnt(4)
    v_mfma_f32_16x16x32_bf16 v[128:131], v[32:35], a[192:195], v[128:131]
    ds_read_b64_tr_b16 v[48:49], v16 offset:4096
    v_mfma_f32_16x16x32_bf16 v[132:135], v[32:35], a[196:199], v[132:135]
    ds_read_b64_tr_b16 v[50:51], v16 offset:4608
    v_mfma_f32_16x16x32_bf16 v[136:139], v[32:35], a[200:203], v[136:139]
    ds_read_b64_tr_b16 v[52:53], v16 offset:12288
    v_mfma_f32_16x16x32_bf16 v[140:143], v[32:35], a[204:207], v[140:143]
    ds_read_b64_tr_b16 v[54:55], v16 offset:12800
    v_mfma_f32_16x16x32_bf16 v[144:147], v[36:39], a[192:195], v[144:147]
    v_mfma_f32_16x16x32_bf16 v[148:151], v[36:39], a[196:199], v[148:151]
    buffer_load_dwordx4 a[12:15], v27, s[32:35], s50 offen sc1
    v_mfma_f32_16x16x32_bf16 v[152:155], v[36:39], a[200:203], v[152:155]
    v_mfma_f32_16x16x32_bf16 v[156:159], v[36:39], a[204:207], v[156:159]
    s_waitcnt lgkmcnt(4)
    v_mfma_f32_16x16x32_bf16 v[160:163], v[40:43], a[192:195], v[160:163]
    ds_read_b64_tr_b16 v[56:57], v17 offset:4096
    v_mfma_f32_16x16x32_bf16 v[164:167], v[40:43], a[196:199], v[164:167]
    ds_read_b64_tr_b16 v[58:59], v17 offset:4608
    s_mov_b32 s50, 0x2000
    buffer_load_dwordx4 a[16:19], v24, s[32:35], s50 offen sc1
    v_mfma_f32_16x16x32_bf16 v[168:171], v[40:43], a[200:203], v[168:171]
    ds_read_b64_tr_b16 v[60:61], v17 offset:12288
    v_mfma_f32_16x16x32_bf16 v[172:175], v[40:43], a[204:207], v[172:175]
    ds_read_b64_tr_b16 v[62:63], v17 offset:12800
    v_mfma_f32_16x16x32_bf16 v[176:179], v[44:47], a[192:195], v[176:179]
    v_mfma_f32_16x16x32_bf16 v[180:183], v[44:47], a[196:199], v[180:183]
    buffer_load_dwordx4 a[20:23], v25, s[32:35], s50 offen sc1
    v_mfma_f32_16x16x32_bf16 v[184:187], v[44:47], a[200:203], v[184:187]
    v_mfma_f32_16x16x32_bf16 v[188:191], v[44:47], a[204:207], v[188:191]
    s_waitcnt lgkmcnt(0)
    s_barrier
    v_mfma_f32_16x16x32_bf16 v[128:131], v[48:51], a[208:211], v[128:131]
    v_mfma_f32_16x16x32_bf16 v[132:135], v[48:51], a[212:215], v[132:135]
    v_mfma_f32_16x16x32_bf16 v[136:139], v[48:51], a[216:219], v[136:139]
    v_mfma_f32_16x16x32_bf16 v[140:143], v[48:51], a[220:223], v[140:143]
    v_mfma_f32_16x16x32_bf16 v[144:147], v[52:55], a[208:211], v[144:147]
    v_mfma_f32_16x16x32_bf16 v[148:151], v[52:55], a[212:215], v[148:151]
    buffer_load_dwordx4 a[24:27], v26, s[32:35], s50 offen sc1
    v_mfma_f32_16x16x32_bf16 v[152:155], v[52:55], a[216:219], v[152:155]
    v_mfma_f32_16x16x32_bf16 v[156:159], v[52:55], a[220:223], v[156:159]
    v_mfma_f32_16x16x32_bf16 v[160:163], v[56:59], a[208:211], v[160:163]
    v_mfma_f32_16x16x32_bf16 v[164:167], v[56:59], a[212:215], v[164:167]
    buffer_load_dwordx4 a[28:31], v27, s[32:35], s50 offen sc1
    v_mfma_f32_16x16x32_bf16 v[168:171], v[56:59], a[216:219], v[168:171]
    v_mfma_f32_16x16x32_bf16 v[172:175], v[56:59], a[220:223], v[172:175]
    v_mfma_f32_16x16x32_bf16 v[176:179], v[60:63], a[208:211], v[176:179]
    v_mfma_f32_16x16x32_bf16 v[180:183], v[60:63], a[212:215], v[180:183]
    s_mov_b32 s50, 0x4000
    buffer_load_dwordx4 a[32:35], v24, s[32:35], s50 offen sc1
    v_mfma_f32_16x16x32_bf16 v[184:187], v[60:63], a[216:219], v[184:187]
    v_mfma_f32_16x16x32_bf16 v[188:191], v[60:63], a[220:223], v[188:191]
    s_nop 4
    v_pk_mul_f32 v[128:129], v[128:129], s[4:5]
    buffer_load_dwordx4 a[36:39], v25, s[32:35], s50 offen sc1
    v_pk_mul_f32 v[130:131], v[130:131], s[4:5]
    v_pk_mul_f32 v[160:161], v[160:161], s[4:5]
    v_pk_mul_f32 v[162:163], v[162:163], s[4:5]
    v_exp_f32 v128, v128
    v_exp_f32 v129, v129
    v_exp_f32 v130, v130
    v_exp_f32 v131, v131
    v_exp_f32 v160, v160
    v_exp_f32 v161, v161
    v_exp_f32 v162, v162
    buffer_load_dwordx4 a[40:43], v26, s[32:35], s50 offen sc1
    v_exp_f32 v163, v163
    v_pk_add_f32 v[128:129], v[128:129], s[6:7]
    v_pk_add_f32 v[130:131], v[130:131], s[6:7]
    v_pk_add_f32 v[160:161], v[160:161], s[6:7]
    v_pk_add_f32 v[162:163], v[162:163], s[6:7]
    v_rcp_f32 v128, v128
    v_rcp_f32 v129, v129
    v_rcp_f32 v130, v130
    v_rcp_f32 v131, v131
    v_rcp_f32 v160, v160
    buffer_load_dwordx4 a[44:47], v27, s[32:35], s50 offen sc1
    v_rcp_f32 v161, v161
    v_rcp_f32 v162, v162
    v_rcp_f32 v163, v163
    v_pk_mul_f32 v[128:129], v[128:129], v[144:145]
    v_pk_mul_f32 v[130:131], v[130:131], v[146:147]
    v_pk_mul_f32 v[160:161], v[160:161], v[176:177]
    v_pk_mul_f32 v[162:163], v[162:163], v[178:179]
    v_cvt_pk_bf16_f32 v144, v128, v129
    v_cvt_pk_bf16_f32 v145, v130, v131
    v_cvt_pk_bf16_f32 v146, v160, v161
    s_mov_b32 s50, 0x6000
    buffer_load_dwordx4 a[48:51], v24, s[32:35], s50 offen sc1
    v_cvt_pk_bf16_f32 v147, v162, v163
    s_add_u32 s47, s47, 0xfffd6800
    buffer_store_dwordx4 v[144:147], v22, s[32:35], s47 offen sc1
    v_pk_mul_f32 v[132:133], v[132:133], s[4:5]
    v_pk_mul_f32 v[134:135], v[134:135], s[4:5]
    v_pk_mul_f32 v[164:165], v[164:165], s[4:5]
    v_pk_mul_f32 v[166:167], v[166:167], s[4:5]
    v_exp_f32 v132, v132
    v_exp_f32 v133, v133
    v_exp_f32 v134, v134
    v_exp_f32 v135, v135
    buffer_load_dwordx4 a[52:55], v25, s[32:35], s50 offen sc1
    v_exp_f32 v164, v164
    v_exp_f32 v165, v165
    v_exp_f32 v166, v166
    v_exp_f32 v167, v167
    v_pk_add_f32 v[132:133], v[132:133], s[6:7]
    v_pk_add_f32 v[134:135], v[134:135], s[6:7]
    v_pk_add_f32 v[164:165], v[164:165], s[6:7]
    v_pk_add_f32 v[166:167], v[166:167], s[6:7]
    v_rcp_f32 v132, v132
    v_rcp_f32 v133, v133
    buffer_load_dwordx4 a[56:59], v26, s[32:35], s50 offen sc1
    v_rcp_f32 v134, v134
    v_rcp_f32 v135, v135
    v_rcp_f32 v164, v164
    v_rcp_f32 v165, v165
    v_rcp_f32 v166, v166
    v_rcp_f32 v167, v167
    v_pk_mul_f32 v[132:133], v[132:133], v[148:149]
    v_pk_mul_f32 v[134:135], v[134:135], v[150:151]
    v_pk_mul_f32 v[164:165], v[164:165], v[180:181]
    v_pk_mul_f32 v[166:167], v[166:167], v[182:183]
    buffer_load_dwordx4 a[60:63], v27, s[32:35], s50 offen sc1
    v_cvt_pk_bf16_f32 v148, v132, v133
    v_cvt_pk_bf16_f32 v149, v134, v135
    v_cvt_pk_bf16_f32 v150, v164, v165
    v_cvt_pk_bf16_f32 v151, v166, v167
    s_add_u32 s47, s47, 0xe000
    buffer_store_dwordx4 v[148:151], v22, s[32:35], s47 offen sc1
    v_pk_mul_f32 v[136:137], v[136:137], s[4:5]
    v_pk_mul_f32 v[138:139], v[138:139], s[4:5]
    v_pk_mul_f32 v[168:169], v[168:169], s[4:5]
    v_pk_mul_f32 v[170:171], v[170:171], s[4:5]
    v_exp_f32 v136, v136
    s_mov_b32 s50, 0x8000
    buffer_load_dwordx4 a[64:67], v24, s[32:35], s50 offen sc1
    v_exp_f32 v137, v137
    v_exp_f32 v138, v138
    v_exp_f32 v139, v139
    v_exp_f32 v168, v168
    v_exp_f32 v169, v169
    v_exp_f32 v170, v170
    v_exp_f32 v171, v171
    v_pk_add_f32 v[136:137], v[136:137], s[6:7]
    v_pk_add_f32 v[138:139], v[138:139], s[6:7]
    v_pk_add_f32 v[168:169], v[168:169], s[6:7]
    buffer_load_dwordx4 a[68:71], v25, s[32:35], s50 offen sc1
    v_pk_add_f32 v[170:171], v[170:171], s[6:7]
    v_rcp_f32 v136, v136
    v_rcp_f32 v137, v137
    v_rcp_f32 v138, v138
    v_rcp_f32 v139, v139
    v_rcp_f32 v168, v168
    v_rcp_f32 v169, v169
    v_rcp_f32 v170, v170
    v_rcp_f32 v171, v171
    v_pk_mul_f32 v[136:137], v[136:137], v[152:153]
    buffer_load_dwordx4 a[72:75], v26, s[32:35], s50 offen sc1
    v_pk_mul_f32 v[138:139], v[138:139], v[154:155]
    v_pk_mul_f32 v[168:169], v[168:169], v[184:185]
    v_pk_mul_f32 v[170:171], v[170:171], v[186:187]
    v_cvt_pk_bf16_f32 v152, v136, v137
    v_cvt_pk_bf16_f32 v153, v138, v139
    v_cvt_pk_bf16_f32 v154, v168, v169
    v_cvt_pk_bf16_f32 v155, v170, v171
    s_add_u32 s47, s47, 0xe000
    buffer_store_dwordx4 v[152:155], v22, s[32:35], s47 offen sc1
    v_pk_mul_f32 v[140:141], v[140:141], s[4:5]
    v_pk_mul_f32 v[142:143], v[142:143], s[4:5]
    buffer_load_dwordx4 a[76:79], v27, s[32:35], s50 offen sc1
    v_pk_mul_f32 v[172:173], v[172:173], s[4:5]
    v_pk_mul_f32 v[174:175], v[174:175], s[4:5]
    v_exp_f32 v140, v140
    v_exp_f32 v141, v141
    v_exp_f32 v142, v142
    v_exp_f32 v143, v143
    v_exp_f32 v172, v172
    v_exp_f32 v173, v173
    v_exp_f32 v174, v174
    v_exp_f32 v175, v175
    s_mov_b32 s50, 0xa000
    buffer_load_dwordx4 a[80:83], v24, s[32:35], s50 offen sc1
    v_pk_add_f32 v[140:141], v[140:141], s[6:7]
    v_pk_add_f32 v[142:143], v[142:143], s[6:7]
    v_pk_add_f32 v[172:173], v[172:173], s[6:7]
    v_pk_add_f32 v[174:175], v[174:175], s[6:7]
    v_rcp_f32 v140, v140
    v_rcp_f32 v141, v141
    v_rcp_f32 v142, v142
    v_rcp_f32 v143, v143
    v_rcp_f32 v172, v172
    v_rcp_f32 v173, v173
    buffer_load_dwordx4 a[84:87], v25, s[32:35], s50 offen sc1
    v_rcp_f32 v174, v174
    v_rcp_f32 v175, v175
    v_pk_mul_f32 v[140:141], v[140:141], v[156:157]
    v_pk_mul_f32 v[142:143], v[142:143], v[158:159]
    v_pk_mul_f32 v[172:173], v[172:173], v[188:189]
    v_pk_mul_f32 v[174:175], v[174:175], v[190:191]
    v_cvt_pk_bf16_f32 v156, v140, v141
    v_cvt_pk_bf16_f32 v157, v142, v143
    v_cvt_pk_bf16_f32 v158, v172, v173
    v_cvt_pk_bf16_f32 v159, v174, v175
    buffer_load_dwordx4 a[88:91], v26, s[32:35], s50 offen sc1
    s_add_u32 s47, s47, 0xe000
    buffer_store_dwordx4 v[156:159], v22, s[32:35], s47 offen sc1
    s_waitcnt vmcnt(52)
    ds_read_b64_tr_b16 v[32:33], v220 offset:16384
    ds_read_b64_tr_b16 v[34:35], v220 offset:18432
    ds_read_b64_tr_b16 v[36:37], v221 offset:16384
    ds_read_b64_tr_b16 v[38:39], v221 offset:18432
    ds_read_b64_tr_b16 v[40:41], v222 offset:16384
    ds_read_b64_tr_b16 v[42:43], v222 offset:18432
    ds_read_b64_tr_b16 v[44:45], v223 offset:16384
    ds_read_b64_tr_b16 v[46:47], v223 offset:18432
    s_waitcnt vmcnt(26) lgkmcnt(0)
    v_mfma_f32_16x16x32_bf16 v[128:131], v[32:35], a[0:3], 0
    v_mfma_f32_16x16x32_bf16 v[132:135], v[36:39], a[0:3], 0
    buffer_load_dwordx4 a[92:95], v27, s[32:35], s50 offen sc1
    v_mfma_f32_16x16x32_bf16 v[136:139], v[40:43], a[0:3], 0
    v_mfma_f32_16x16x32_bf16 v[140:143], v[44:47], a[0:3], 0
    s_waitcnt vmcnt(26)
    v_mfma_f32_16x16x32_bf16 v[144:147], v[32:35], a[4:7], 0
    ds_read_b64_tr_b16 v[48:49], v220 offset:32768
    v_mfma_f32_16x16x32_bf16 v[148:151], v[36:39], a[4:7], 0
    ds_read_b64_tr_b16 v[50:51], v220 offset:34816
    s_mov_b32 s50, 0xc000
    buffer_load_dwordx4 a[96:99], v24, s[32:35], s50 offen sc1
    v_mfma_f32_16x16x32_bf16 v[152:155], v[40:43], a[4:7], 0
    ds_read_b64_tr_b16 v[52:53], v221 offset:32768
    v_mfma_f32_16x16x32_bf16 v[156:159], v[44:47], a[4:7], 0
    ds_read_b64_tr_b16 v[54:55], v221 offset:34816
    s_waitcnt vmcnt(26)
    v_mfma_f32_16x16x32_bf16 v[160:163], v[32:35], a[8:11], 0
    ds_read_b64_tr_b16 v[56:57], v222 offset:32768
    v_mfma_f32_16x16x32_bf16 v[164:167], v[36:39], a[8:11], 0
    ds_read_b64_tr_b16 v[58:59], v222 offset:34816
    buffer_load_dwordx4 a[100:103], v25, s[32:35], s50 offen sc1
    v_mfma_f32_16x16x32_bf16 v[168:171], v[40:43], a[8:11], 0
    ds_read_b64_tr_b16 v[60:61], v223 offset:32768
    v_mfma_f32_16x16x32_bf16 v[172:175], v[44:47], a[8:11], 0
    ds_read_b64_tr_b16 v[62:63], v223 offset:34816
    s_waitcnt vmcnt(26)
    v_mfma_f32_16x16x32_bf16 v[176:179], v[32:35], a[12:15], 0
    v_mfma_f32_16x16x32_bf16 v[180:183], v[36:39], a[12:15], 0
    buffer_load_dwordx4 a[104:107], v26, s[32:35], s50 offen sc1
    v_mfma_f32_16x16x32_bf16 v[184:187], v[40:43], a[12:15], 0
    v_mfma_f32_16x16x32_bf16 v[188:191], v[44:47], a[12:15], 0
    s_waitcnt vmcnt(26) lgkmcnt(0)
    v_mfma_f32_16x16x32_bf16 v[128:131], v[48:51], a[16:19], v[128:131]
    v_mfma_f32_16x16x32_bf16 v[132:135], v[52:55], a[16:19], v[132:135]
    buffer_load_dwordx4 a[108:111], v27, s[32:35], s50 offen sc1
    v_mfma_f32_16x16x32_bf16 v[136:139], v[56:59], a[16:19], v[136:139]
    v_mfma_f32_16x16x32_bf16 v[140:143], v[60:63], a[16:19], v[140:143]
    s_waitcnt vmcnt(26)
    v_mfma_f32_16x16x32_bf16 v[144:147], v[48:51], a[20:23], v[144:147]
    ds_read_b64_tr_b16 v[32:33], v220 offset:49152
    v_mfma_f32_16x16x32_bf16 v[148:151], v[52:55], a[20:23], v[148:151]
    ds_read_b64_tr_b16 v[34:35], v220 offset:51200
    buffer_load_dwordx4 v192, s[28:31], s45 offen lds
    v_mfma_f32_16x16x32_bf16 v[152:155], v[56:59], a[20:23], v[152:155]
    ds_read_b64_tr_b16 v[36:37], v221 offset:49152
    v_mfma_f32_16x16x32_bf16 v[156:159], v[60:63], a[20:23], v[156:159]
    ds_read_b64_tr_b16 v[38:39], v221 offset:51200
    s_waitcnt vmcnt(6)
    s_barrier
    s_cmp_lg_u32 s42, 1
    s_cbranch_scc1 L_nosig1
    s_mov_b64 exec, 0x3fff
    global_store_dword v23, v201, s[16:17] offset:64 sc1
    s_mov_b64 exec, -1
L_nosig1:
    v_mfma_f32_16x16x32_bf16 v[160:163], v[48:51], a[24:27], v[160:163]
    ds_read_b64_tr_b16 v[40:41], v222 offset:49152
    v_mfma_f32_16x16x32_bf16 v[164:167], v[52:55], a[24:27], v[164:167]
    ds_read_b64_tr_b16 v[42:43], v222 offset:51200
    buffer_load_dwordx4 v193, s[28:31], s45 offen offset:1024 lds
    v_mfma_f32_16x16x32_bf16 v[168:171], v[56:59], a[24:27], v[168:171]
    ds_read_b64_tr_b16 v[44:45], v223 offset:49152
    v_mfma_f32_16x16x32_bf16 v[172:175], v[60:63], a[24:27], v[172:175]
    ds_read_b64_tr_b16 v[46:47], v223 offset:51200
    s_waitcnt vmcnt(26)
    v_mfma_f32_16x16x32_bf16 v[176:179], v[48:51], a[28:31], v[176:179]
    v_mfma_f32_16x16x32_bf16 v[180:183], v[52:55], a[28:31], v[180:183]
    buffer_load_dwordx4 v194, s[28:31], s45 offen offset:2048 lds
    v_mfma_f32_16x16x32_bf16 v[184:187], v[56:59], a[28:31], v[184:187]
    v_mfma_f32_16x16x32_bf16 v[188:191], v[60:63], a[28:31], v[188:191]
    s_waitcnt vmcnt(26) lgkmcnt(0)
    v_mfma_f32_16x16x32_bf16 v[128:131], v[32:35], a[32:35], v[128:131]
    v_mfma_f32_16x16x32_bf16 v[132:135], v[36:39], a[32:35], v[132:135]
    buffer_load_dwordx4 v195, s[28:31], s45 offen offset:3072 lds
    v_mfma_f32_16x16x32_bf16 v[136:139], v[40:43], a[32:35], v[136:139]
    v_mfma_f32_16x16x32_bf16 v[140:143], v[44:47], a[32:35], v[140:143]
    s_waitcnt vmcnt(26)
    v_mfma_f32_16x16x32_bf16 v[144:147], v[32:35], a[36:39], v[144:147]
    ds_read_b64_tr_b16 v[48:49], v224 offset:0
    v_mfma_f32_16x16x32_bf16 v[148:151], v[36:39], a[36:39], v[148:151]
    ds_read_b64_tr_b16 v[50:51], v224 offset:2048
    s_add_u32 m0, s46, 0x24000
    s_add_u32 s45, s48, 0x46000
    buffer_load_dwordx4 v192, s[28:31], s45 offen lds
    v_mfma_f32_16x16x32_bf16 v[152:155], v[40:43], a[36:39], v[152:155]
    ds_read_b64_tr_b16 v[52:53], v225 offset:0
    v_mfma_f32_16x16x32_bf16 v[156:159], v[44:47], a[36:39], v[156:159]
    ds_read_b64_tr_b16 v[54:55], v225 offset:2048
    s_waitcnt vmcnt(26)
    v_mfma_f32_16x16x32_bf16 v[160:163], v[32:35], a[40:43], v[160:163]
    ds_read_b64_tr_b16 v[56:57], v226 offset:0
    v_mfma_f32_16x16x32_bf16 v[164:167], v[36:39], a[40:43], v[164:167]
    ds_read_b64_tr_b16 v[58:59], v226 offset:2048
    buffer_load_dwordx4 v193, s[28:31], s45 offen offset:1024 lds
    v_mfma_f32_16x16x32_bf16 v[168:171], v[40:43], a[40:43], v[168:171]
    ds_read_b64_tr_b16 v[60:61], v227 offset:0
    v_mfma_f32_16x16x32_bf16 v[172:175], v[44:47], a[40:43], v[172:175]
    ds_read_b64_tr_b16 v[62:63], v227 offset:2048
    s_waitcnt vmcnt(26)
    v_mfma_f32_16x16x32_bf16 v[176:179], v[32:35], a[44:47], v[176:179]
    v_mfma_f32_16x16x32_bf16 v[180:183], v[36:39], a[44:47], v[180:183]
    buffer_load_dwordx4 v194, s[28:31], s45 offen offset:2048 lds
    v_mfma_f32_16x16x32_bf16 v[184:187], v[40:43], a[44:47], v[184:187]
    v_mfma_f32_16x16x32_bf16 v[188:191], v[44:47], a[44:47], v[188:191]
    s_waitcnt vmcnt(26) lgkmcnt(0)
    v_mfma_f32_16x16x32_bf16 v[128:131], v[48:51], a[48:51], v[128:131]
    v_mfma_f32_16x16x32_bf16 v[132:135], v[52:55], a[48:51], v[132:135]
    buffer_load_dwordx4 v195, s[28:31], s45 offen offset:3072 lds
    v_mfma_f32_16x16x32_bf16 v[136:139], v[56:59], a[48:51], v[136:139]
    v_mfma_f32_16x16x32_bf16 v[140:143], v[60:63], a[48:51], v[140:143]
    s_waitcnt vmcnt(25)
    v_mfma_f32_16x16x32_bf16 v[144:147], v[48:51], a[52:55], v[144:147]
    ds_read_b64_tr_b16 v[32:33], v224 offset:16384
    v_mfma_f32_16x16x32_bf16 v[148:151], v[52:55], a[52:55], v[148:151]
    ds_read_b64_tr_b16 v[34:35], v224 offset:18432
    s_add_u32 m0, s46, 0x0
    s_add_u32 s45, s48, 0x7e000
    buffer_load_dwordx4 v192, s[28:31], s45 offen lds
    v_mfma_f32_16x16x32_bf16 v[152:155], v[56:59], a[52:55], v[152:155]
    ds_read_b64_tr_b16 v[36:37], v225 offset:16384
    v_mfma_f32_16x16x32_bf16 v[156:159], v[60:63], a[52:55], v[156:159]
    ds_read_b64_tr_b16 v[38:39], v225 offset:18432
    s_waitcnt vmcnt(25)
    v_mfma_f32_16x16x32_bf16 v[160:163], v[48:51], a[56:59], v[160:163]
    ds_read_b64_tr_b16 v[40:41], v226 offset:16384
    v_mfma_f32_16x16x32_bf16 v[164:167], v[52:55], a[56:59], v[164:167]
    ds_read_b64_tr_b16 v[42:43], v226 offset:18432
    buffer_load_dwordx4 v193, s[28:31], s45 offen offset:1024 lds
    v_mfma_f32_16x16x32_bf16 v[168:171], v[56:59], a[56:59], v[168:171]
    ds_read_b64_tr_b16 v[44:45], v227 offset:16384
    v_mfma_f32_16x16x32_bf16 v[172:175], v[60:63], a[56:59], v[172:175]
    ds_read_b64_tr_b16 v[46:47], v227 offset:18432
    s_waitcnt vmcnt(25)
    v_mfma_f32_16x16x32_bf16 v[176:179], v[48:51], a[60:63], v[176:179]
    v_mfma_f32_16x16x32_bf16 v[180:183], v[52:55], a[60:63], v[180:183]
    buffer_load_dwordx4 v194, s[28:31], s45 offen offset:2048 lds
    v_mfma_f32_16x16x32_bf16 v[184:187], v[56:59], a[60:63], v[184:187]
    v_mfma_f32_16x16x32_bf16 v[188:191], v[60:63], a[60:63], v[188:191]
    s_waitcnt vmcnt(24) lgkmcnt(0)
    v_mfma_f32_16x16x32_bf16 v[128:131], v[32:35], a[64:67], v[128:131]
    v_mfma_f32_16x16x32_bf16 v[132:135], v[36:39], a[64:67], v[132:135]
    buffer_load_dwordx4 v195, s[28:31], s45 offen offset:3072 lds
    v_mfma_f32_16x16x32_bf16 v[136:139], v[40:43], a[64:67], v[136:139]
    v_mfma_f32_16x16x32_bf16 v[140:143], v[44:47], a[64:67], v[140:143]
    s_waitcnt vmcnt(24)
    v_mfma_f32_16x16x32_bf16 v[144:147], v[32:35], a[68:71], v[144:147]
    ds_read_b64_tr_b16 v[48:49], v224 offset:32768
    v_mfma_f32_16x16x32_bf16 v[148:151], v[36:39], a[68:71], v[148:151]
    ds_read_b64_tr_b16 v[50:51], v224 offset:34816
    s_add_u32 m0, s46, 0x4000
    s_add_u32 s45, s48, 0xb6000
    buffer_load_dwordx4 v192, s[28:31], s45 offen lds
    v_mfma_f32_16x16x32_bf16 v[152:155], v[40:43], a[68:71], v[152:155]
    ds_read_b64_tr_b16 v[52:53], v225 offset:32768
    v_mfma_f32_16x16x32_bf16 v[156:159], v[44:47], a[68:71], v[156:159]
    ds_read_b64_tr_b16 v[54:55], v225 offset:34816
    s_cmp_lg_u32 s42, 1
    s_cbranch_scc1 L_npi1
    global_load_dword v200, v196, s[16:17] offset:64 sc1
L_npi1:
    s_waitcnt vmcnt(24)
    v_mfma_f32_16x16x32_bf16 v[160:163], v[32:35], a[72:75], v[160:163]
    ds_read_b64_tr_b16 v[56:57], v226 offset:32768
    v_mfma_f32_16x16x32_bf16 v[164:167], v[36:39], a[72:75], v[164:167]
    ds_read_b64_tr_b16 v[58:59], v226 offset:34816
    buffer_load_dwordx4 v193, s[28:31], s45 offen offset:1024 lds
    v_mfma_f32_16x16x32_bf16 v[168:171], v[40:43], a[72:75], v[168:171]
    ds_read_b64_tr_b16 v[60:61], v227 offset:32768
    v_mfma_f32_16x16x32_bf16 v[172:175], v[44:47], a[72:75], v[172:175]
    ds_read_b64_tr_b16 v[62:63], v227 offset:34816
    s_waitcnt vmcnt(23)
    v_mfma_f32_16x16x32_bf16 v[176:179], v[32:35], a[76:79], v[176:179]
    v_mfma_f32_16x16x32_bf16 v[180:183], v[36:39], a[76:79], v[180:183]
    buffer_load_dwordx4 v194, s[28:31], s45 offen offset:2048 lds
    v_mfma_f32_16x16x32_bf16 v[184:187], v[40:43], a[76:79], v[184:187]
    v_mfma_f32_16x16x32_bf16 v[188:191], v[44:47], a[76:79], v[188:191]
    s_waitcnt vmcnt(23) lgkmcnt(0)
    v_mfma_f32_16x16x32_bf16 v[128:131], v[48:51], a[80:83], v[128:131]
    v_mfma_f32_16x16x32_bf16 v[132:135], v[52:55], a[80:83], v[132:135]
    buffer_load_dwordx4 v195, s[28:31], s45 offen offset:3072 lds
    v_mfma_f32_16x16x32_bf16 v[136:139], v[56:59], a[80:83], v[136:139]
    v_mfma_f32_16x16x32_bf16 v[140:143], v[60:63], a[80:83], v[140:143]
    s_waitcnt vmcnt(23)
    v_mfma_f32_16x16x32_bf16 v[144:147], v[48:51], a[84:87], v[144:147]
    ds_read_b64_tr_b16 v[32:33], v224 offset:49152
    v_mfma_f32_16x16x32_bf16 v[148:151], v[52:55], a[84:87], v[148:151]
    ds_read_b64_tr_b16 v[34:35], v224 offset:51200
    s_add_u32 m0, s46, 0x8000
    s_add_u32 s45, s48, 0xee000
    buffer_load_dwordx4 v192, s[28:31], s45 offen lds
    v_mfma_f32_16x16x32_bf16 v[152:155], v[56:59], a[84:87], v[152:155]
    ds_read_b64_tr_b16 v[36:37], v225 offset:49152
    v_mfma_f32_16x16x32_bf16 v[156:159], v[60:63], a[84:87], v[156:159]
    ds_read_b64_tr_b16 v[38:39], v225 offset:51200
    buffer_load_dwordx4 v193, s[28:31], s45 offen offset:1024 lds
    buffer_load_dwordx4 v194, s[28:31], s45 offen offset:2048 lds
    buffer_load_dwordx4 v195, s[28:31], s45 offen offset:3072 lds
    s_add_u32 m0, s46, 0xc000
    s_add_u32 s45, s48, 0x126000
    buffer_load_dwordx4 v192, s[28:31], s45 offen lds
    s_cmp_lg_u32 s42, 1
    s_cbranch_scc1 L_pok1
    s_waitcnt vmcnt(8)
    s_mov_b32 s61, 0
L_poll1:
    v_cmp_ne_u32 vcc, 1, v200
    s_addk_i32 s61, 1
    s_cmp_ge_u32 s61, 0x40000
    s_cbranch_scc1 L_pok1
    s_cmp_eq_u64 vcc, 0
    s_cbranch_scc1 L_pok1
    s_sleep 2
    global_load_dword v200, v196, s[16:17] offset:64 sc1
    s_waitcnt vmcnt(0)
    s_branch L_poll1
L_pok1:
    s_barrier
    buffer_load_dwordx4 v193, s[28:31], s45 offen offset:1024 lds
    buffer_load_dwordx4 v194, s[28:31], s45 offen offset:2048 lds
    buffer_load_dwordx4 v195, s[28:31], s45 offen offset:3072 lds
    s_add_u32 m0, s46, 0x10000
    s_add_u32 s45, s48, 0x15e000
    buffer_load_dwordx4 v192, s[28:31], s45 offen lds
    buffer_load_dwordx4 v193, s[28:31], s45 offen offset:1024 lds
    buffer_load_dwordx4 v194, s[28:31], s45 offen offset:2048 lds
    buffer_load_dwordx4 v195, s[28:31], s45 offen offset:3072 lds
    s_mov_b32 s50, 0x0
    buffer_load_dwordx4 a[112:115], v24, s[32:35], s50 offen offset:2048 sc1
    s_waitcnt vmcnt(35)
    v_mfma_f32_16x16x32_bf16 v[160:163], v[48:51], a[88:91], v[160:163]
    ds_read_b64_tr_b16 v[40:41], v226 offset:49152
    v_mfma_f32_16x16x32_bf16 v[164:167], v[52:55], a[88:91], v[164:167]
    ds_read_b64_tr_b16 v[42:43], v226 offset:51200
    buffer_load_dwordx4 a[116:119], v25, s[32:35], s50 offen offset:2048 sc1
    v_mfma_f32_16x16x32_bf16 v[168:171], v[56:59], a[88:91], v[168:171]
    ds_read_b64_tr_b16 v[44:45], v227 offset:49152
    v_mfma_f32_16x16x32_bf16 v[172:175], v[60:63], a[88:91], v[172:175]
    ds_read_b64_tr_b16 v[46:47], v227 offset:51200
    s_waitcnt vmcnt(34)
    v_mfma_f32_16x16x32_bf16 v[176:179], v[48:51], a[92:95], v[176:179]
    v_mfma_f32_16x16x32_bf16 v[180:183], v[52:55], a[92:95], v[180:183]
    buffer_load_dwordx4 a[120:123], v26, s[32:35], s50 offen offset:2048 sc1
    v_mfma_f32_16x16x32_bf16 v[184:187], v[56:59], a[92:95], v[184:187]
    v_mfma_f32_16x16x32_bf16 v[188:191], v[60:63], a[92:95], v[188:191]
    s_waitcnt vmcnt(34) lgkmcnt(0)
    v_mfma_f32_16x16x32_bf16 v[128:131], v[32:35], a[96:99], v[128:131]
    v_mfma_f32_16x16x32_bf16 v[132:135], v[36:39], a[96:99], v[132:135]
    buffer_load_dwordx4 a[124:127], v27, s[32:35], s50 offen offset:2048 sc1
    v_mfma_f32_16x16x32_bf16 v[136:139], v[40:43], a[96:99], v[136:139]
    v_mfma_f32_16x16x32_bf16 v[140:143], v[44:47], a[96:99], v[140:143]
    s_waitcnt vmcnt(28)
    v_mfma_f32_16x16x32_bf16 v[144:147], v[32:35], a[100:103], v[144:147]
    ds_read_b64_tr_b16 v[48:49], v228 offset:0
    v_mfma_f32_16x16x32_bf16 v[148:151], v[36:39], a[100:103], v[148:151]
    ds_read_b64_tr_b16 v[50:51], v228 offset:2048
    s_mov_b32 s50, 0x2000
    buffer_load_dwordx4 a[128:131], v24, s[32:35], s50 offen offset:2048 sc1
    v_mfma_f32_16x16x32_bf16 v[152:155], v[40:43], a[100:103], v[152:155]
    ds_read_b64_tr_b16 v[52:53], v229 offset:0
    v_mfma_f32_16x16x32_bf16 v[156:159], v[44:47], a[100:103], v[156:159]
    ds_read_b64_tr_b16 v[54:55], v229 offset:2048
    s_waitcnt vmcnt(34)
    v_mfma_f32_16x16x32_bf16 v[160:163], v[32:35], a[104:107], v[160:163]
    ds_read_b64_tr_b16 v[56:57], v230 offset:0
    v_mfma_f32_16x16x32_bf16 v[164:167], v[36:39], a[104:107], v[164:167]
    ds_read_b64_tr_b16 v[58:59], v230 offset:2048
    buffer_load_dwordx4 a[132:135], v25, s[32:35], s50 offen offset:2048 sc1
    v_mfma_f32_16x16x32_bf16 v[168:171], v[40:43], a[104:107], v[168:171]
    ds_read_b64_tr_b16 v[60:61], v231 offset:0
    v_mfma_f32_16x16x32_bf16 v[172:175], v[44:47], a[104:107], v[172:175]
    ds_read_b64_tr_b16 v[62:63], v231 offset:2048
    s_waitcnt vmcnt(34)
    v_mfma_f32_16x16x32_bf16 v[176:179], v[32:35], a[108:111], v[176:179]
    v_mfma_f32_16x16x32_bf16 v[180:183], v[36:39], a[108:111], v[180:183]
    buffer_load_dwordx4 a[136:139], v26, s[32:35], s50 offen offset:2048 sc1
    v_mfma_f32_16x16x32_bf16 v[184:187], v[40:43], a[108:111], v[184:187]
    v_mfma_f32_16x16x32_bf16 v[188:191], v[44:47], a[108:111], v[188:191]
    s_waitcnt vmcnt(6) lgkmcnt(0)
    v_mfma_f32_16x16x32_bf16 v[128:131], v[48:51], a[112:115], v[128:131]
    v_mfma_f32_16x16x32_bf16 v[132:135], v[52:55], a[112:115], v[132:135]
    buffer_load_dwordx4 a[140:143], v27, s[32:35], s50 offen offset:2048 sc1
    v_mfma_f32_16x16x32_bf16 v[136:139], v[56:59], a[112:115], v[136:139]
    v_mfma_f32_16x16x32_bf16 v[140:143], v[60:63], a[112:115], v[140:143]
    s_waitcnt vmcnt(6)
    v_mfma_f32_16x16x32_bf16 v[144:147], v[48:51], a[116:119], v[144:147]
    ds_read_b64_tr_b16 v[32:33], v228 offset:16384
    v_mfma_f32_16x16x32_bf16 v[148:151], v[52:55], a[116:119], v[148:151]
    ds_read_b64_tr_b16 v[34:35], v228 offset:18432
    s_mov_b32 s50, 0x4000
    buffer_load_dwordx4 a[144:147], v24, s[32:35], s50 offen offset:2048 sc1
    v_mfma_f32_16x16x32_bf16 v[152:155], v[56:59], a[116:119], v[152:155]
    ds_read_b64_tr_b16 v[36:37], v229 offset:16384
    v_mfma_f32_16x16x32_bf16 v[156:159], v[60:63], a[116:119], v[156:159]
    ds_read_b64_tr_b16 v[38:39], v229 offset:18432
    s_waitcnt vmcnt(6)
    v_mfma_f32_16x16x32_bf16 v[160:163], v[48:51], a[120:123], v[160:163]
    ds_read_b64_tr_b16 v[40:41], v230 offset:16384
    v_mfma_f32_16x16x32_bf16 v[164:167], v[52:55], a[120:123], v[164:167]
    ds_read_b64_tr_b16 v[42:43], v230 offset:18432
    buffer_load_dwordx4 a[148:151], v25, s[32:35], s50 offen offset:2048 sc1
    v_mfma_f32_16x16x32_bf16 v[168:171], v[56:59], a[120:123], v[168:171]
    ds_read_b64_tr_b16 v[44:45], v231 offset:16384
    v_mfma_f32_16x16x32_bf16 v[172:175], v[60:63], a[120:123], v[172:175]
    ds_read_b64_tr_b16 v[46:47], v231 offset:18432
    s_waitcnt vmcnt(6)
    v_mfma_f32_16x16x32_bf16 v[176:179], v[48:51], a[124:127], v[176:179]
    v_mfma_f32_16x16x32_bf16 v[180:183], v[52:55], a[124:127], v[180:183]
    buffer_load_dwordx4 a[152:155], v26, s[32:35], s50 offen offset:2048 sc1
    v_mfma_f32_16x16x32_bf16 v[184:187], v[56:59], a[124:127], v[184:187]
    v_mfma_f32_16x16x32_bf16 v[188:191], v[60:63], a[124:127], v[188:191]
    s_waitcnt vmcnt(6) lgkmcnt(0)
    v_mfma_f32_16x16x32_bf16 v[128:131], v[32:35], a[128:131], v[128:131]
    v_mfma_f32_16x16x32_bf16 v[132:135], v[36:39], a[128:131], v[132:135]
    buffer_load_dwordx4 a[156:159], v27, s[32:35], s50 offen offset:2048 sc1
    v_mfma_f32_16x16x32_bf16 v[136:139], v[40:43], a[128:131], v[136:139]
    v_mfma_f32_16x16x32_bf16 v[140:143], v[44:47], a[128:131], v[140:143]
    s_waitcnt vmcnt(6)
    v_mfma_f32_16x16x32_bf16 v[144:147], v[32:35], a[132:135], v[144:147]
    ds_read_b64_tr_b16 v[48:49], v220 offset:0
    v_mfma_f32_16x16x32_bf16 v[148:151], v[36:39], a[132:135], v[148:151]
    ds_read_b64_tr_b16 v[50:51], v220 offset:2048
    s_mov_b32 s50, 0x6000
    buffer_load_dwordx4 a[160:163], v24, s[32:35], s50 offen offset:2048 sc1
    v_mfma_f32_16x16x32_bf16 v[152:155], v[40:43], a[132:135], v[152:155]
    ds_read_b64_tr_b16 v[52:53], v221 offset:0
    v_mfma_f32_16x16x32_bf16 v[156:159], v[44:47], a[132:135], v[156:159]
    ds_read_b64_tr_b16 v[54:55], v221 offset:2048
    s_waitcnt vmcnt(6)
    v_mfma_f32_16x16x32_bf16 v[160:163], v[32:35], a[136:139], v[160:163]
    ds_read_b64_tr_b16 v[56:57], v222 offset:0
    v_mfma_f32_16x16x32_bf16 v[164:167], v[36:39], a[136:139], v[164:167]
    ds_read_b64_tr_b16 v[58:59], v222 offset:2048
    buffer_load_dwordx4 a[164:167], v25, s[32:35], s50 offen offset:2048 sc1
    v_mfma_f32_16x16x32_bf16 v[168:171], v[40:43], a[136:139], v[168:171]
    ds_read_b64_tr_b16 v[60:61], v223 offset:0
    v_mfma_f32_16x16x32_bf16 v[172:175], v[44:47], a[136:139], v[172:175]
    ds_read_b64_tr_b16 v[62:63], v223 offset:2048
    s_waitcnt vmcnt(6)
    v_mfma_f32_16x16x32_bf16 v[176:179], v[32:35], a[140:143], v[176:179]
    v_mfma_f32_16x16x32_bf16 v[180:183], v[36:39], a[140:143], v[180:183]
    buffer_load_dwordx4 a[168:171], v26, s[32:35], s50 offen offset:2048 sc1
    v_mfma_f32_16x16x32_bf16 v[184:187], v[40:43], a[140:143], v[184:187]
    v_mfma_f32_16x16x32_bf16 v[188:191], v[44:47], a[140:143], v[188:191]
    s_waitcnt vmcnt(6) lgkmcnt(0)
    v_mfma_f32_16x16x32_bf16 v[128:131], v[48:51], a[144:147], v[128:131]
    v_mfma_f32_16x16x32_bf16 v[132:135], v[52:55], a[144:147], v[132:135]
    buffer_load_dwordx4 a[172:175], v27, s[32:35], s50 offen offset:2048 sc1
    v_mfma_f32_16x16x32_bf16 v[136:139], v[56:59], a[144:147], v[136:139]
    v_mfma_f32_16x16x32_bf16 v[140:143], v[60:63], a[144:147], v[140:143]
    s_waitcnt vmcnt(6)
    v_mfma_f32_16x16x32_bf16 v[144:147], v[48:51], a[148:151], v[144:147]
    ds_read_b64_tr_b16 v[32:33], v220 offset:16384
    v_mfma_f32_16x16x32_bf16 v[148:151], v[52:55], a[148:151], v[148:151]
    ds_read_b64_tr_b16 v[34:35], v220 offset:18432
    s_mov_b32 s50, 0x8000
    buffer_load_dwordx4 a[180:183], v25, s[32:35], s50 offen offset:2048 sc1
    v_mfma_f32_16x16x32_bf16 v[152:155], v[56:59], a[148:151], v[152:155]
    ds_read_b64_tr_b16 v[36:37], v221 offset:16384
    v_mfma_f32_16x16x32_bf16 v[156:159], v[60:63], a[148:151], v[156:159]
    ds_read_b64_tr_b16 v[38:39], v221 offset:18432
    s_waitcnt vmcnt(6)
    v_mfma_f32_16x16x32_bf16 v[160:163], v[48:51], a[152:155], v[160:163]
    ds_read_b64_tr_b16 v[40:41], v222 offset:16384
    v_mfma_f32_16x16x32_bf16 v[164:167], v[52:55], a[152:155], v[164:167]
    ds_read_b64_tr_b16 v[42:43], v222 offset:18432
    s_mov_b32 s50, 0xa000
    buffer_load_dwordx4 a[196:199], v25, s[32:35], s50 offen offset:2048 sc1
    v_mfma_f32_16x16x32_bf16 v[168:171], v[56:59], a[152:155], v[168:171]
    ds_read_b64_tr_b16 v[44:45], v223 offset:16384
    v_mfma_f32_16x16x32_bf16 v[172:175], v[60:63], a[152:155], v[172:175]
    ds_read_b64_tr_b16 v[46:47], v223 offset:18432
    s_waitcnt vmcnt(6)
    v_mfma_f32_16x16x32_bf16 v[176:179], v[48:51], a[156:159], v[176:179]
    v_mfma_f32_16x16x32_bf16 v[180:183], v[52:55], a[156:159], v[180:183]
    s_mov_b32 s50, 0xc000
    buffer_load_dwordx4 a[212:215], v25, s[32:35], s50 offen offset:2048 sc1
    v_mfma_f32_16x16x32_bf16 v[184:187], v[56:59], a[156:159], v[184:187]
    v_mfma_f32_16x16x32_bf16 v[188:191], v[60:63], a[156:159], v[188:191]
    s_waitcnt vmcnt(6) lgkmcnt(0)
    v_mfma_f32_16x16x32_bf16 v[128:131], v[32:35], a[160:163], v[128:131]
    v_mfma_f32_16x16x32_bf16 v[132:135], v[36:39], a[160:163], v[132:135]
    s_mov_b32 s50, 0x8000
    buffer_load_dwordx4 a[184:187], v26, s[32:35], s50 offen offset:2048 sc1
    v_mfma_f32_16x16x32_bf16 v[136:139], v[40:43], a[160:163], v[136:139]
    v_mfma_f32_16x16x32_bf16 v[140:143], v[44:47], a[160:163], v[140:143]
    s_waitcnt vmcnt(6)
    v_mfma_f32_16x16x32_bf16 v[144:147], v[32:35], a[164:167], v[144:147]
    ds_read_b64_tr_b16 v[48:49], v220 offset:32768
    ds_read_b64_tr_b16 v[50:51], v220 offset:34816
    ds_read_b64_tr_b16 v[52:53], v221 offset:32768
    v_mfma_f32_16x16x32_bf16 v[148:151], v[36:39], a[164:167], v[148:151]
    ds_read_b64_tr_b16 v[54:55], v221 offset:34816
    ds_read_b64_tr_b16 v[56:57], v222 offset:32768
    ds_read_b64_tr_b16 v[58:59], v222 offset:34816
    s_mov_b32 s50, 0xa000
    buffer_load_dwordx4 a[200:203], v26, s[32:35], s50 offen offset:2048 sc1
    v_mfma_f32_16x16x32_bf16 v[152:155], v[40:43], a[164:167], v[152:155]
    ds_read_b64_tr_b16 v[60:61], v223 offset:32768
    ds_read_b64_tr_b16 v[62:63], v223 offset:34816
    ds_read_b64_tr_b16 v[80:81], v220 offset:49152
    v_mfma_f32_16x16x32_bf16 v[156:159], v[44:47], a[164:167], v[156:159]
    ds_read_b64_tr_b16 v[82:83], v220 offset:51200
    ds_read_b64_tr_b16 v[84:85], v221 offset:49152
    ds_read_b64_tr_b16 v[86:87], v221 offset:51200
    s_waitcnt vmcnt(6)
    v_mfma_f32_16x16x32_bf16 v[160:163], v[32:35], a[168:171], v[160:163]
    ds_read_b64_tr_b16 v[88:89], v222 offset:49152
    ds_read_b64_tr_b16 v[90:91], v222 offset:51200
    ds_read_b64_tr_b16 v[92:93], v223 offset:49152
    v_mfma_f32_16x16x32_bf16 v[164:167], v[36:39], a[168:171], v[164:167]
    ds_read_b64_tr_b16 v[94:95], v223 offset:51200
    ds_read_b64_tr_b16 v[64:65], v224 offset:0
    ds_read_b64_tr_b16 v[66:67], v224 offset:2048
    s_mov_b32 s50, 0xc000
    buffer_load_dwordx4 a[216:219], v26, s[32:35], s50 offen offset:2048 sc1
    v_mfma_f32_16x16x32_bf16 v[168:171], v[40:43], a[168:171], v[168:171]
    ds_read_b64_tr_b16 v[68:69], v225 offset:0
    v_mfma_f32_16x16x32_bf16 v[172:175], v[44:47], a[168:171], v[172:175]
    ds_read_b64_tr_b16 v[70:71], v225 offset:2048
    s_waitcnt vmcnt(6)
    v_mfma_f32_16x16x32_bf16 v[176:179], v[32:35], a[172:175], v[176:179]
    ds_read_b64_tr_b16 v[72:73], v226 offset:0
    v_mfma_f32_16x16x32_bf16 v[180:183], v[36:39], a[172:175], v[180:183]
    ds_read_b64_tr_b16 v[74:75], v226 offset:2048
    s_mov_b32 s50, 0x8000
    buffer_load_dwordx4 a[188:191], v27, s[32:35], s50 offen offset:2048 sc1
    v_mfma_f32_16x16x32_bf16 v[184:187], v[40:43], a[172:175], v[184:187]
    ds_read_b64_tr_b16 v[76:77], v227 offset:0
    v_mfma_f32_16x16x32_bf16 v[188:191], v[44:47], a[172:175], v[188:191]
    ds_read_b64_tr_b16 v[78:79], v227 offset:2048
    s_waitcnt vmcnt(6) lgkmcnt(0)
    v_mfma_f32_16x16x32_bf16 v[144:147], v[48:51], a[180:183], v[144:147]
    v_mfma_f32_16x16x32_bf16 v[148:151], v[52:55], a[180:183], v[148:151]
    s_mov_b32 s50, 0xa000
    buffer_load_dwordx4 a[204:207], v27, s[32:35], s50 offen offset:2048 sc1
    v_mfma_f32_16x16x32_bf16 v[152:155], v[56:59], a[180:183], v[152:155]
    v_mfma_f32_16x16x32_bf16 v[156:159], v[60:63], a[180:183], v[156:159]
    s_waitcnt vmcnt(6)
    v_mfma_f32_16x16x32_bf16 v[144:147], v[80:83], a[196:199], v[144:147]
    v_mfma_f32_16x16x32_bf16 v[148:151], v[84:87], a[196:199], v[148:151]
    s_mov_b32 s50, 0xc000
    buffer_load_dwordx4 a[220:223], v27, s[32:35], s50 offen offset:2048 sc1
    v_mfma_f32_16x16x32_bf16 v[152:155], v[88:91], a[196:199], v[152:155]
    v_mfma_f32_16x16x32_bf16 v[156:159], v[92:95], a[196:199], v[156:159]
    s_waitcnt vmcnt(6)
    v_mfma_f32_16x16x32_bf16 v[144:147], v[64:67], a[212:215], v[144:147]
    v_mfma_f32_16x16x32_bf16 v[148:151], v[68:71], a[212:215], v[148:151]
    s_mov_b32 s50, 0x8000
    buffer_load_dwordx4 a[176:179], v24, s[32:35], s50 offen offset:2048 sc1
    v_mfma_f32_16x16x32_bf16 v[152:155], v[72:75], a[212:215], v[152:155]
    v_mfma_f32_16x16x32_bf16 v[156:159], v[76:79], a[212:215], v[156:159]
    s_waitcnt vmcnt(6)
    v_mfma_f32_16x16x32_bf16 v[160:163], v[48:51], a[184:187], v[160:163]
    v_mfma_f32_16x16x32_bf16 v[164:167], v[52:55], a[184:187], v[164:167]
    s_mov_b32 s50, 0xa000
    buffer_load_dwordx4 a[192:195], v24, s[32:35], s50 offen offset:2048 sc1
    v_mfma_f32_16x16x32_bf16 v[168:171], v[56:59], a[184:187], v[168:171]
    v_mfma_f32_16x16x32_bf16 v[172:175], v[60:63], a[184:187], v[172:175]
    s_waitcnt vmcnt(6)
    v_mfma_f32_16x16x32_bf16 v[160:163], v[80:83], a[200:203], v[160:163]
    v_mfma_f32_16x16x32_bf16 v[164:167], v[84:87], a[200:203], v[164:167]
    ds_write_b128 v216, v[144:147] offset:16384
    s_mov_b32 s50, 0xc000
    buffer_load_dwordx4 a[208:211], v24, s[32:35], s50 offen offset:2048 sc1
    v_mfma_f32_16x16x32_bf16 v[168:171], v[88:91], a[200:203], v[168:171]
    v_mfma_f32_16x16x32_bf16 v[172:175], v[92:95], a[200:203], v[172:175]
    ds_write_b128 v216, v[148:151] offset:17408
    s_waitcnt vmcnt(6)
    v_mfma_f32_16x16x32_bf16 v[160:163], v[64:67], a[216:219], v[160:163]
    v_mfma_f32_16x16x32_bf16 v[164:167], v[68:71], a[216:219], v[164:167]
    ds_write_b128 v216, v[152:155] offset:18432
    v_mfma_f32_16x16x32_bf16 v[168:171], v[72:75], a[216:219], v[168:171]
    v_mfma_f32_16x16x32_bf16 v[172:175], v[76:79], a[216:219], v[172:175]
    ds_write_b128 v216, v[156:159] offset:19456
    s_waitcnt vmcnt(5)
    v_mfma_f32_16x16x32_bf16 v[176:179], v[48:51], a[188:191], v[176:179]
    v_mfma_f32_16x16x32_bf16 v[180:183], v[52:55], a[188:191], v[180:183]
    v_mfma_f32_16x16x32_bf16 v[184:187], v[56:59], a[188:191], v[184:187]
    v_mfma_f32_16x16x32_bf16 v[188:191], v[60:63], a[188:191], v[188:191]
    s_waitcnt vmcnt(4)
    v_mfma_f32_16x16x32_bf16 v[176:179], v[80:83], a[204:207], v[176:179]
    v_mfma_f32_16x16x32_bf16 v[180:183], v[84:87], a[204:207], v[180:183]
    ds_write_b128 v216, v[160:163] offset:32768
    v_mfma_f32_16x16x32_bf16 v[184:187], v[88:91], a[204:207], v[184:187]
    v_mfma_f32_16x16x32_bf16 v[188:191], v[92:95], a[204:207], v[188:191]
    ds_write_b128 v216, v[164:167] offset:33792
    s_waitcnt vmcnt(3)
    v_mfma_f32_16x16x32_bf16 v[176:179], v[64:67], a[220:223], v[176:179]
    v_mfma_f32_16x16x32_bf16 v[180:183], v[68:71], a[220:223], v[180:183]
    ds_write_b128 v216, v[168:171] offset:34816
    v_mfma_f32_16x16x32_bf16 v[184:187], v[72:75], a[220:223], v[184:187]
    v_mfma_f32_16x16x32_bf16 v[188:191], v[76:79], a[220:223], v[188:191]
    ds_write_b128 v216, v[172:175] offset:35840
    s_waitcnt vmcnt(2)
    v_mfma_f32_16x16x32_bf16 v[128:131], v[48:51], a[176:179], v[128:131]
    v_mfma_f32_16x16x32_bf16 v[132:135], v[52:55], a[176:179], v[132:135]
    v_mfma_f32_16x16x32_bf16 v[136:139], v[56:59], a[176:179], v[136:139]
    v_mfma_f32_16x16x32_bf16 v[140:143], v[60:63], a[176:179], v[140:143]
    s_waitcnt vmcnt(1)
    v_mfma_f32_16x16x32_bf16 v[128:131], v[80:83], a[192:195], v[128:131]
    v_mfma_f32_16x16x32_bf16 v[132:135], v[84:87], a[192:195], v[132:135]
    ds_write_b128 v216, v[176:179] offset:49152
    v_mfma_f32_16x16x32_bf16 v[136:139], v[88:91], a[192:195], v[136:139]
    v_mfma_f32_16x16x32_bf16 v[140:143], v[92:95], a[192:195], v[140:143]
    ds_write_b128 v216, v[180:183] offset:50176
    s_waitcnt vmcnt(0)
    v_mfma_f32_16x16x32_bf16 v[128:131], v[64:67], a[208:211], v[128:131]
    v_mfma_f32_16x16x32_bf16 v[132:135], v[68:71], a[208:211], v[132:135]
    ds_write_b128 v216, v[184:187] offset:51200
    v_mfma_f32_16x16x32_bf16 v[136:139], v[72:75], a[208:211], v[136:139]
    v_mfma_f32_16x16x32_bf16 v[140:143], v[76:79], a[208:211], v[140:143]
    ds_write_b128 v216, v[188:191] offset:52224
    s_waitcnt lgkmcnt(0)
    s_barrier
    ds_read_b128 v[144:147], v217 offset:16384
    ds_read_b128 v[148:151], v217 offset:17408
    ds_read_b128 v[152:155], v217 offset:18432
    ds_read_b128 v[156:159], v217 offset:19456
    ds_read_b128 v[160:163], v218 offset:32768
    ds_read_b128 v[164:167], v218 offset:33792
    ds_read_b128 v[168:171], v218 offset:34816
    ds_read_b128 v[172:175], v218 offset:35840
    ds_read_b128 v[176:179], v219 offset:49152
    ds_read_b128 v[180:183], v219 offset:50176
    ds_read_b128 v[184:187], v219 offset:51200
    ds_read_b128 v[188:191], v219 offset:52224
    s_waitcnt lgkmcnt(8)
    v_pk_add_f32 v[128:129], v[128:129], v[144:145]
    v_pk_add_f32 v[130:131], v[130:131], v[146:147]
    v_pk_add_f32 v[132:133], v[132:133], v[148:149]
    v_pk_add_f32 v[134:135], v[134:135], v[150:151]
    v_pk_add_f32 v[136:137], v[136:137], v[152:153]
    v_pk_add_f32 v[138:139], v[138:139], v[154:155]
    v_pk_add_f32 v[140:141], v[140:141], v[156:157]
    v_pk_add_f32 v[142:143], v[142:143], v[158:159]
    s_waitcnt lgkmcnt(4)
    v_pk_add_f32 v[128:129], v[128:129], v[160:161]
    v_pk_add_f32 v[130:131], v[130:131], v[162:163]
    v_pk_add_f32 v[132:133], v[132:133], v[164:165]
    v_pk_add_f32 v[134:135], v[134:135], v[166:167]
    v_pk_add_f32 v[136:137], v[136:137], v[168:169]
    v_pk_add_f32 v[138:139], v[138:139], v[170:171]
    v_pk_add_f32 v[140:141], v[140:141], v[172:173]
    v_pk_add_f32 v[142:143], v[142:143], v[174:175]
    s_waitcnt lgkmcnt(0)
    v_pk_add_f32 v[128:129], v[128:129], v[176:177]
    v_pk_add_f32 v[130:131], v[130:131], v[178:179]
    v_pk_add_f32 v[132:133], v[132:133], v[180:181]
    v_pk_add_f32 v[134:135], v[134:135], v[182:183]
    v_pk_add_f32 v[136:137], v[136:137], v[184:185]
    v_pk_add_f32 v[138:139], v[138:139], v[186:187]
    v_pk_add_f32 v[140:141], v[140:141], v[188:189]
    v_pk_add_f32 v[142:143], v[142:143], v[190:191]
    v_cvt_pk_bf16_f32 v144, v128, v129
    v_cvt_pk_bf16_f32 v145, v130, v131
    v_cvt_pk_bf16_f32 v146, v132, v133
    v_cvt_pk_bf16_f32 v147, v134, v135
    v_cvt_pk_bf16_f32 v148, v136, v137
    v_cvt_pk_bf16_f32 v149, v138, v139
    v_cvt_pk_bf16_f32 v150, v140, v141
    v_cvt_pk_bf16_f32 v151, v142, v143
    s_nop 1
    v_permlane16_swap_b32 v144, v146
    v_permlane16_swap_b32 v145, v147
    v_permlane16_swap_b32 v148, v150
    v_permlane16_swap_b32 v149, v151
    buffer_store_dwordx4 v[144:147], v199, s[36:39], s8 offen
    buffer_store_dwordx4 v[148:151], v199, s[36:39], s8 offen offset:64
    s_endpgm
L_help2:
    s_and_b32 s41, s40, 7
    s_lshr_b32 s42, s40, 3
    s_lshr_b32 s43, s41, 1
    s_lshl_b32 s43, s43, 2
    s_add_u32 s43, s43, s42
    s_mul_i32 s44, s43, 100352
    s_and_b32 s45, s41, 1
    s_mul_i32 s45, s45, 1792
    s_add_u32 s44, s44, s45
    s_addk_i32 s44, 128
    v_mul_u32_u24 v1, 9363, v0
    v_lshrrev_b32 v1, 16, v1
    v_mul_u32_u24 v2, 7, v1
    v_sub_u32 v2, v0, v2
    v_mul_u32_u24 v1, 3584, v1
    v_lshl_add_u32 v1, v2, 8, v1
    v_mov_b32 v3, 0x7fffffff
    v_cmp_gt_u32 vcc, 196, v0
    v_lshlrev_b32 v4, 7, v0
    s_lshl_b32 s46, s41, 2
    v_cndmask_b32 v1, v3, v1, vcc
    v_cndmask_b32 v5, v3, v4, vcc
    v_cmp_gt_u32 vcc, 224, v0
    s_add_u32 s46, s46, s42
    s_mul_i32 s46, s46, 50176
    v_cndmask_b32 v6, v3, v4, vcc
    s_waitcnt lgkmcnt(0)
    s_mov_b32 s20, s6
    s_and_b32 s21, s7, 0xffff
    s_mov_b32 s22, 1605632
    s_mov_b32 s23, 0x20000
    s_mov_b32 s24, s8
    s_and_b32 s25, s9, 0xffff
    s_mov_b32 s26, 1605632
    s_mov_b32 s27, 0x20000
    s_mov_b32 s28, s10
    s_and_b32 s29, s11, 0xffff
    s_mov_b32 s30, 1605632
    s_mov_b32 s31, 0x20000
    s_mul_i32 s49, s40, 896
    s_add_u32 s49, s49, 0x800000
    v_lshl_add_u32 v14, v0, 2, s49
    v_mov_b32 v15, 0
    s_and_saveexec_b64 s[32:33], vcc
    global_store_dword v14, v15, s[16:17] sc1
    s_mov_b64 exec, -1
    s_waitcnt vmcnt(0)
    s_barrier
    v_lshlrev_b32 v14, 7, v0
    v_mov_b32 v15, 1
    v_cmp_gt_u32 vcc, 2, v0
    s_and_saveexec_b64 s[32:33], vcc
    s_cbranch_execz L_nha
    global_atomic_add v14, v15, s[14:15] sc1
L_nha:
    s_mov_b64 exec, -1
    buffer_load_dword v8, v1, s[20:23], s44 offen
    buffer_load_dword v9, v1, s[24:27], s44 offen
    buffer_load_dword v10, v5, s[28:31], s46 offen
    s_add_u32 s46, s46, 25088
    buffer_load_dword v11, v5, s[28:31], s46 offen
    s_waitcnt vmcnt(0)
L_end2:
    s_endpgm
.section .rodata,"a"
.p2align 6
.amdhsa_kernel standalone__glu_gated_glu__prompt_kernel
  .amdhsa_next_free_vgpr 512
  .amdhsa_next_free_sgpr 102
  .amdhsa_accum_offset 256
  .amdhsa_group_segment_fixed_size 0
  .amdhsa_kernarg_size 56
  .amdhsa_user_sgpr_count 2
  .amdhsa_user_sgpr_kernarg_segment_ptr 1
  .amdhsa_system_sgpr_workgroup_id_x 1
.end_amdhsa_kernel
```
